```python
import torch

def _softmax(x, axis=-1):
    return torch.softmax(x, dim=axis)
def _gelu(x):
    return torch.nn.functional.gelu(x, approximate="tanh")
def _silu(x):
    return torch.nn.functional.silu(x)
def _sigmoid(x):
    return torch.sigmoid(x)
def _layernorm(x, axis=-1, eps=1e-5):
    m = x.mean(dim=axis, keepdim=True)
    v = x.var(dim=axis, keepdim=True, unbiased=False)
    return (x - m) / torch.sqrt(v + eps)
def _scatter_add(tgt, idx, src, axis=0):
    return tgt.clone().index_add_(axis, idx, src)
def _segment_sum(src, seg, n):
    out = torch.zeros((n,) + src.shape[1:], dtype=src.dtype)
    return out.index_add_(0, seg, src)
def _pad(x, pw):
    flat = tuple(v for pair in reversed(pw) for v in pair)
    return torch.nn.functional.pad(x, flat)

kernel_name = 'parallel_sum__compressed_kv_cla__dense_activation_squared_relu__decode'

def setup_inputs():

    _w = (lambda a: (lambda t: t.to(torch.bfloat16) if t.is_floating_point() else t)(torch.as_tensor(a)))
    def _A_setup():
        B, H, Sq, Sk, D, M = 2, 32, 1, 4096, 192, 640
        Dc = 4 * D
        return {
            "x": _w((lambda *s: torch.randn(*s, dtype=torch.bfloat16) * 0.05)(B, Sq, M)),
            "c_kv": _w((lambda *s: torch.randn(*s, dtype=torch.bfloat16) * 3.2)(B, Sk, Dc)),
            "w_q": _w((lambda *s: torch.randn(*s, dtype=torch.bfloat16) * 1.6)(M, H, D) * (M ** -0.5)),
            "w_uk": _w((lambda *s: torch.randn(*s, dtype=torch.bfloat16) * 1.6)(Dc, H, D) * (Dc ** -0.5)),
            "w_uv": _w((lambda *s: torch.randn(*s, dtype=torch.bfloat16) * 3.2)(Dc, H, D) * (Dc ** -0.5)),
            "w_o": _w((lambda *s: torch.randn(*s, dtype=torch.bfloat16) * 3.2)(H, D, M) * ((H * D) ** -0.5)),
        }
    _A_in = _A_setup()

    def _B_setup():
        B, S, D, F = 2, 1, 640, 1536
        return {
            "x": _w((lambda *s: torch.randn(*s, dtype=torch.bfloat16) * 0.05)(B, S, D)),
            "w1": _w((lambda *s: torch.randn(*s, dtype=torch.bfloat16) * 0.1)(D, F)),
            "b1": _w((lambda *s: torch.randn(*s, dtype=torch.bfloat16) * 0.8)(F)),
            "w2": _w((lambda *s: torch.randn(*s, dtype=torch.bfloat16) * 0.1)(F, D)),
            "b2": _w((lambda *s: torch.randn(*s, dtype=torch.bfloat16) * 12.8)(D)),
        }
    _B_in = _B_setup()

    return {
        "A_x": _A_in["x"],
        "A_c_kv": _A_in["c_kv"],
        "A_w_q": _A_in["w_q"],
        "A_w_uk": _A_in["w_uk"],
        "A_w_uv": _A_in["w_uv"],
        "A_w_o": _A_in["w_o"],
        "B_x": _B_in["x"],
        "B_w1": _B_in["w1"],
        "B_b1": _B_in["b1"],
        "B_w2": _B_in["w2"],
        "B_b2": _B_in["b2"],
    }

def reference(A_x, A_c_kv, A_w_q, A_w_uk, A_w_uv, A_w_o, B_x, B_w1, B_b1, B_w2, B_b2):
    def _A_ref(x, c_kv, w_q, w_uk, w_uv, w_o):
        B, Sq, M = x.shape[0], x.shape[1], x.shape[2]
        Sk = c_kv.shape[1]
        H, D = w_q.shape[1], w_q.shape[2]
        q = torch.einsum("bqm,mhd->bhqd", x, w_q)
        k = torch.einsum("bkc,chd->bhkd", c_kv, w_uk)
        v = torch.einsum("bkc,chd->bhkd", c_kv, w_uv)
        scores = torch.einsum("bhqd,bhkd->bhqk", q, k) * (D ** -0.5)
        off = Sk - Sq
        qi = torch.arange(Sq)[:, None]
        kj = torch.arange(Sk)[None, :]
        cmask = kj <= (qi + off)
        scores = torch.where(cmask[None, None], scores, -1e9)
        p = _softmax(scores, axis=-1)
        ctx = torch.einsum("bhqk,bhkd->bhqd", p, v)
        return torch.einsum("bhqd,hdm->bqm", ctx, w_o)

    def _B_ref(x, w1, b1, w2, b2):
        h = torch.einsum("bsd,df->bsf", x, w1) + b1
        zero = torch.zeros_like(h)
        r = torch.where(h > zero, h, zero)
        h = r * r
        out = torch.einsum("bsf,fd->bsd", h, w2) + b2
        return out

    x = A_x
    xn = _layernorm(x, axis=-1)
    return x + _A_ref(xn, A_c_kv, A_w_q, A_w_uk, A_w_uv, A_w_o) + _B_ref(xn, B_w1, B_b1, B_w2, B_b2)
```

```asm
; @launch grid=(256,1,1) block=(256,1,1) lds=156160
.amdgcn_target "amdgcn-amd-amdhsa--gfx950"
.set CODE_BYTES, L_code_end-parallel_sum__compressed_kv_cla__dense_activation_squared_relu__decode_kernel
.set CODE_LINES, (CODE_BYTES+127)/128
.set CODE_LINES1, CODE_LINES
.set CODE_LINES2, CODE_LINES-64
.text
.globl parallel_sum__compressed_kv_cla__dense_activation_squared_relu__decode_kernel
.p2align 8
.type parallel_sum__compressed_kv_cla__dense_activation_squared_relu__decode_kernel,@function
parallel_sum__compressed_kv_cla__dense_activation_squared_relu__decode_kernel:
    s_cmp_ge_u32 s2, 256
    s_cbranch_scc1 L_exit
    s_load_dwordx16 s[64:79], s[0:1], 0
    s_load_dwordx8 s[80:87], s[0:1], 64
    s_load_dwordx4 s[88:91], s[0:1], 96
    v_mov_b32 v14, v0
    v_lshrrev_b32 v30, 6, v0
    v_and_b32 v0, 63, v0
    v_readfirstlane_b32 s48, v30
    s_getpc_b64 s[54:55]
L_pc:
    s_sub_u32 s54, s54, L_pc-parallel_sum__compressed_kv_cla__dense_activation_squared_relu__decode_kernel
    s_subb_u32 s55, s55, 0
    s_cmp_lg_u32 s48, 0
    s_cbranch_scc1 L_nopf
    v_lshlrev_b32 v33, 7, v0
    v_cmp_gt_u32 vcc, CODE_LINES1, v0
    s_nop 0
    s_and_saveexec_b64 s[60:61], vcc
    s_cbranch_execz L_nopf1
    global_load_dword v62, v33, s[54:55]
L_nopf1:
    s_mov_b64 exec, -1
    v_add_u32 v33, 8192, v33
    v_cmp_gt_u32 vcc, CODE_LINES2, v0
    s_nop 0
    s_and_saveexec_b64 s[60:61], vcc
    s_cbranch_execz L_nopf2
    global_load_dword v62, v33, s[54:55]
L_nopf2:
    s_mov_b64 exec, -1
L_nopf:
    v_lshrrev_b32 v12, 4, v0
    v_and_b32 v13, 15, v0
    s_and_b32 s54, s2, 7
    s_lshr_b32 s55, s2, 3
    s_lshl_b32 s49, s54, 2
    s_lshr_b32 s56, s55, 3
    s_add_u32 s49, s49, s56
    s_and_b32 s50, s55, 7
    s_lshr_b32 s51, s49, 4
    s_and_b32 s52, s49, 15
    v_lshrrev_b32 v30, 5, v0
    v_mul_u32_u24 v30, 1280, v30
    v_and_b32 v31, 31, v0
    v_mul_u32_u24 v31, 40, v31
    v_add_u32 v30, v30, v31
    v_mul_u32_u24 v6, 12288, v12
    v_lshl_add_u32 v6, v13, 4, v6
    v_and_b32 v31, 7, v13
    v_mul_u32_u24 v7, 12288, v12
    v_lshl_add_u32 v7, v31, 4, v7
    v_add_u32 v7, 256, v7
    v_mov_b32 v31, 2130706432
    v_cmp_gt_u32 vcc, 8, v13
    s_nop 1
    v_cndmask_b32 v29, v31, v7, vcc
    v_lshrrev_b32 v31, 3, v13
    v_mul_u32_u24 v31, 49152, v31
    v_add_u32 v7, v7, v31
    s_mov_b32 s10, 7864320
    s_mov_b32 s11, 0x00020000
    s_mov_b32 s34, 268435456
    s_mov_b32 s35, 0x00020000
    s_mul_i32 s54, s50, 983040
    s_mul_i32 s55, s48, 245760
    s_add_u32 s54, s54, s55
    s_mul_i32 s55, s49, 384
    s_add_u32 s59, s54, s55
    v_mov_b32 v32, 0
    s_mul_hi_u32 s92, s2, 0x15555556
    s_mul_i32 s54, s92, 12
    s_sub_u32 s93, s2, s54
    s_min_u32 s94, s2, 191
    s_min_u32 s54, s2, 79
    s_lshl_b32 s54, s54, 2
    v_and_b32 v36, 3, v0
    v_add_u32 v36, s54, v36
    v_lshrrev_b32 v37, 4, v36
    v_lshlrev_b32 v37, 5, v37
    v_and_b32 v38, 7, v36
    v_add_u32 v37, v37, v38
    v_bfe_u32 v38, v0, 2, 2
    v_lshl_add_u32 v37, v38, 3, v37
    v_bfe_u32 v38, v36, 3, 1
    v_mul_u32_u24 v38, 640, v38
    v_add_lshl_u32 v17, v38, v37, 1
    v_lshlrev_b32 v37, 1, v37
    s_lshr_b32 s54, s94, 2
    s_lshl_b32 s54, s54, 5
    s_and_b32 s55, s94, 3
    s_lshl_b32 s55, s55, 1
    s_add_u32 s95, s54, s55
    v_lshlrev_b32 v38, 3, v12
    v_add_u32 v38, s95, v38
    v_lshlrev_b32 v38, 1, v38
    s_waitcnt lgkmcnt(0)
    s_mov_b64 s[40:41], s[64:65]
    s_mov_b64 s[8:9], s[68:69]
    s_mov_b64 s[32:33], s[90:91]
    s_cmp_eq_u32 s48, 0
    s_cbranch_scc0 L_nores
    global_load_ushort v15, v17, s[64:65]
    global_load_ushort v63, v37, s[84:85]
L_nores:
    s_cmp_eq_u32 s48, 3
    s_cbranch_scc0 L_nob1
    global_load_dword v16, v38, s[80:81]
L_nob1:
    global_load_dwordx4 v[164:167], v30, s[40:41]
    global_load_dwordx4 v[168:171], v30, s[40:41] offset:16
    global_load_dwordx2 v[172:173], v30, s[40:41] offset:32
    buffer_load_dword v1, v32, s[32:35], 0 offen sc1
    buffer_load_dwordx4 a[0:3], v6, s[8:11], s59 offen
    buffer_load_dwordx4 a[20:23], v7, s[8:11], s59 offen
    s_add_u32 s59, s59, 49152
    buffer_load_dwordx4 a[4:7], v6, s[8:11], s59 offen
    s_add_u32 s59, s59, 49152
    buffer_load_dwordx4 a[8:11], v6, s[8:11], s59 offen
    buffer_load_dwordx4 a[24:27], v7, s[8:11], s59 offen
    s_add_u32 s59, s59, 49152
    buffer_load_dwordx4 a[12:15], v6, s[8:11], s59 offen
    s_add_u32 s59, s59, 49152
    buffer_load_dwordx4 a[16:19], v6, s[8:11], s59 offen
    buffer_load_dwordx4 a[28:31], v29, s[8:11], s59 offen
    s_mov_b64 s[12:13], s[70:71]
    s_mov_b64 s[16:17], s[66:67]
    s_mov_b64 s[20:21], s[72:73]
    s_mov_b64 s[28:29], s[78:79]
    s_mov_b64 s[36:37], s[86:87]
    s_mov_b64 s[42:43], s[80:81]
    s_mov_b64 s[44:45], s[84:85]
    s_cmp_eq_u32 s48, 3
    s_cselect_b32 s24, s82, s74
    s_cselect_b32 s25, s83, s75
    s_mov_b32 s26, 7864320
    s_cselect_b32 s26, 1966080, s26
    s_mov_b32 s14, 9437184
    s_mov_b32 s15, 0x00020000
    s_mov_b32 s18, 12582912
    s_mov_b32 s19, 0x00020000
    s_mov_b32 s22, 9437184
    s_mov_b32 s23, 0x00020000
    s_mov_b32 s30, 1966080
    s_mov_b32 s31, 0x00020000
    s_mov_b32 s38, 2560
    s_mov_b32 s39, 0x00020000
    s_mov_b32 s27, 0x00020000
    s_mov_b32 s3, 0x07060503
    s_mov_b32 s4, 0x07060502
    s_mov_b32 s5, 0x07060501
    s_mov_b32 s6, 0x04000c0c
    s_mov_b32 s7, 0x0706000c
    s_mov_b32 s89, s95
    v_and_b32 v40, 1, v0
    v_lshlrev_b32 v40, 4, v40
    v_mov_b32 v41, 0xffff
    v_lshlrev_b32 v40, v40, v41
    v_bfe_u32 v41, v0, 1, 2
    v_cmp_eq_u32 vcc, 0, v41
    s_nop 1
    v_cndmask_b32 v2, 0, v40, vcc
    v_cmp_eq_u32 vcc, 1, v41
    s_nop 1
    v_cndmask_b32 v3, 0, v40, vcc
    v_cmp_eq_u32 vcc, 2, v41
    s_nop 1
    v_cndmask_b32 v4, 0, v40, vcc
    v_cmp_eq_u32 vcc, 3, v41
    s_nop 1
    v_cndmask_b32 v5, 0, v40, vcc
    v_lshrrev_b32 v40, 3, v0
    v_mul_u32_u24 v8, 12288, v40
    v_and_b32 v40, 7, v0
    v_lshl_add_u32 v8, v40, 4, v8
    v_mul_u32_u24 v9, 10240, v12
    v_lshl_add_u32 v9, v13, 4, v9
    v_mul_u32_u24 v10, 3072, v12
    v_lshl_add_u32 v10, v13, 4, v10
    v_lshlrev_b32 v11, 4, v0
    v_add_u32 v40, 0, v0
    v_mul_u32_u24 v41, 5462, v40
    v_lshrrev_b32 v41, 16, v41
    v_mul_u32_u24 v42, 12, v41
    v_sub_u32 v40, v40, v42
    v_bfe_u32 v42, v41, 2, 1
    v_lshlrev_b32 v42, 1, v42
    v_xor_b32 v40, v40, v42
    v_lshrrev_b32 v42, 3, v41
    v_mul_u32_u24 v42, 24, v42
    v_add_u32 v41, v41, v42
    v_mul_u32_u24 v20, 1536, v41
    v_lshl_add_u32 v20, v40, 4, v20
    v_add_u32 v40, 64, v0
    v_mul_u32_u24 v41, 5462, v40
    v_lshrrev_b32 v41, 16, v41
    v_mul_u32_u24 v42, 12, v41
    v_sub_u32 v40, v40, v42
    v_bfe_u32 v42, v41, 2, 1
    v_lshlrev_b32 v42, 1, v42
    v_xor_b32 v40, v40, v42
    v_lshrrev_b32 v42, 3, v41
    v_mul_u32_u24 v42, 24, v42
    v_add_u32 v41, v41, v42
    v_mul_u32_u24 v21, 1536, v41
    v_lshl_add_u32 v21, v40, 4, v21
    v_add_u32 v40, 128, v0
    v_mul_u32_u24 v41, 5462, v40
    v_lshrrev_b32 v41, 16, v41
    v_mul_u32_u24 v42, 12, v41
    v_sub_u32 v40, v40, v42
    v_bfe_u32 v42, v41, 2, 1
    v_lshlrev_b32 v42, 1, v42
    v_xor_b32 v40, v40, v42
    v_lshrrev_b32 v42, 3, v41
    v_mul_u32_u24 v42, 24, v42
    v_add_u32 v41, v41, v42
    v_mul_u32_u24 v22, 1536, v41
    v_lshl_add_u32 v22, v40, 4, v22
    v_add_u32 v40, 0, v0
    v_mul_u32_u24 v41, 2731, v40
    v_lshrrev_b32 v41, 16, v41
    v_mul_u32_u24 v42, 24, v41
    v_sub_u32 v40, v40, v42
    v_lshrrev_b32 v42, 1, v41
    v_xor_b32 v40, v40, v42
    v_mul_u32_u24 v23, 1536, v41
    v_lshl_add_u32 v23, v40, 4, v23
    v_xor_b32 v26, 64, v23
    v_add_u32 v40, 64, v0
    v_mul_u32_u24 v41, 2731, v40
    v_lshrrev_b32 v41, 16, v41
    v_mul_u32_u24 v42, 24, v41
    v_sub_u32 v40, v40, v42
    v_lshrrev_b32 v42, 1, v41
    v_xor_b32 v40, v40, v42
    v_mul_u32_u24 v24, 1536, v41
    v_lshl_add_u32 v24, v40, 4, v24
    v_xor_b32 v27, 64, v24
    v_add_u32 v40, 128, v0
    v_mul_u32_u24 v41, 2731, v40
    v_lshrrev_b32 v41, 16, v41
    v_mul_u32_u24 v42, 24, v41
    v_sub_u32 v40, v40, v42
    v_lshrrev_b32 v42, 1, v41
    v_xor_b32 v40, v40, v42
    v_mul_u32_u24 v25, 1536, v41
    v_lshl_add_u32 v25, v40, 4, v25
    v_xor_b32 v28, 64, v25
    v_bfe_u32 v40, v0, 3, 1
    v_mul_u32_u24 v40, 640, v40
    v_add_u32 v40, v40, v12
    v_lshlrev_b32 v18, 2, v40
    s_mul_i32 s54, s48, 5120
    s_add_u32 s54, s54, 0
    v_add_u32 v19, s54, v11
    s_lshl_b32 s54, s49, 3
    s_add_u32 s91, s54, s50
    s_lshl_b32 s55, s91, 11
    s_add_u32 s68, s55, 1048576
    s_add_u32 s83, s55, 6291456
    s_lshl_b32 s55, s49, 14
    s_mul_i32 s56, s48, 384
    s_add_u32 s69, s55, s56
    s_add_u32 s69, s69, 1048576
    s_mul_i32 s56, s50, 192
    s_add_u32 s84, s55, s56
    s_lshl_b32 s56, s48, 6
    s_add_u32 s84, s84, s56
    s_add_u32 s84, s84, 6291456
    s_lshr_b32 s55, s50, 1
    s_lshl_b32 s55, s55, 1
    s_add_u32 s55, s55, s51
    s_lshl_b32 s55, s55, 13
    s_lshl_b32 s56, s48, 4
    s_add_u32 s56, s56, s52
    s_lshl_b32 s56, s56, 4
    s_add_u32 s70, s55, s56
    s_add_u32 s70, s70, 65536
    s_lshl_b32 s55, s51, 2
    s_add_u32 s55, s55, s48
    s_lshl_b32 s55, s55, 14
    s_add_u32 s71, s55, 65536
    s_lshl_b32 s54, s51, 12
    s_lshl_b32 s55, s52, 8
    s_add_u32 s54, s54, s55
    s_mul_i32 s54, s54, 1536
    s_mul_i32 s55, s50, 49152
    s_mul_i32 s56, s48, 384
    s_add_u32 s72, s54, s55
    s_add_u32 s72, s72, s56
    s_mul_i32 s55, s48, 98304
    s_mul_i32 s56, s50, 192
    s_add_u32 s73, s54, s55
    s_add_u32 s73, s73, s56
    s_and_b32 s55, s48, 1
    s_lshr_b32 s56, s48, 1
    s_lshl_b32 s54, s91, 2
    s_lshl_b32 s57, s55, 1
    s_add_u32 s54, s54, s57
    s_add_u32 s54, s54, s56
    s_lshl_b32 s54, s54, 10
    s_add_u32 s74, s54, 2097152
    s_lshl_b32 s54, s49, 15
    s_lshl_b32 s57, s55, 11
    s_add_u32 s54, s54, s57
    s_lshl_b32 s57, s56, 14
    s_add_u32 s54, s54, s57
    s_add_u32 s75, s54, 2097152
    s_lshl_b32 s54, s51, 5
    s_lshl_b32 s57, s55, 4
    s_add_u32 s54, s54, s57
    s_lshl_b32 s54, s54, 3
    s_add_u32 s54, s54, s50
    s_lshl_b32 s54, s54, 12
    s_lshl_b32 s57, s52, 8
    s_add_u32 s54, s54, s57
    s_lshl_b32 s57, s56, 7
    s_add_u32 s54, s54, s57
    s_add_u32 s76, s54, 4194304
    s_lshl_b32 s54, s91, 9
    s_lshl_b32 s57, s55, 8
    s_add_u32 s54, s54, s57
    s_add_u32 s77, s54, 196608
    s_lshl_b32 s54, s56, 16
    s_lshl_b32 s57, s50, 9
    s_add_u32 s54, s54, s57
    s_lshl_b32 s57, s49, 4
    s_add_u32 s54, s54, s57
    s_add_u32 s81, s54, 196608
    s_lshl_b32 s54, s56, 8
    s_add_u32 s54, s54, s91
    s_lshl_b32 s54, s54, 12
    s_lshl_b32 s57, s55, 11
    s_add_u32 s54, s54, s57
    s_add_u32 s82, s54, 4194304
    s_mul_i32 s54, s93, 22
    s_add_u32 s54, s54, s92
    s_lshl_b32 s54, s54, 10
    s_add_u32 s78, s54, 327680
    s_lshr_b32 s54, s94, 4
    s_mul_i32 s54, s54, 22528
    s_and_b32 s57, s94, 15
    s_lshl_b32 s57, s57, 6
    s_add_u32 s54, s54, s57
    s_add_u32 s90, s54, 327680
    s_min_u32 s54, s92, 19
    s_lshl_b32 s54, s54, 5
    s_lshl_b32 s57, s48, 3
    s_add_u32 s54, s54, s57
    s_lshl_b32 s88, s54, 2
    s_add_u32 s88, s88, 20480
    s_mul_i32 s54, s54, 3072
    s_lshl_b32 s57, s93, 8
    s_add_u32 s87, s54, s57
    s_mul_i32 s54, s50, 1179648
    s_mul_i32 s57, s56, 589824
    s_add_u32 s54, s54, s57
    s_mul_i32 s57, s49, 384
    s_add_u32 s79, s54, s57
    s_mul_i32 s54, s49, 192
    s_add_u32 s54, s54, s50
    s_lshl_b32 s57, s48, 6
    s_add_u32 s54, s54, s57
    s_cmp_eq_u32 s48, 3
    s_cselect_b32 s54, s89, s54
    s_mul_i32 s80, s54, 1280
    s_and_b32 s54, s2, 7
    s_lshl_b32 s54, s54, 5
    s_lshr_b32 s57, s2, 3
    s_add_u32 s54, s54, s57
    s_lshl_b32 s85, s54, 6
    s_add_u32 s85, s85, 7864320
    s_lshl_b32 s86, s2, 14
    s_lshl_b32 s54, s48, 12
    s_add_u32 s86, s86, s54
    s_add_u32 s86, s86, 7864320
    s_waitcnt vmcnt(9)
    v_lshlrev_b32 v176, 16, v164
    v_and_b32 v177, 0xffff0000, v164
    v_lshlrev_b32 v178, 16, v165
    v_and_b32 v179, 0xffff0000, v165
    v_lshlrev_b32 v180, 16, v166
    v_and_b32 v181, 0xffff0000, v166
    v_lshlrev_b32 v182, 16, v167
    v_and_b32 v183, 0xffff0000, v167
    v_lshlrev_b32 v184, 16, v168
    v_and_b32 v185, 0xffff0000, v168
    v_lshlrev_b32 v186, 16, v169
    v_and_b32 v187, 0xffff0000, v169
    v_lshlrev_b32 v188, 16, v170
    v_and_b32 v189, 0xffff0000, v170
    v_lshlrev_b32 v190, 16, v171
    v_and_b32 v191, 0xffff0000, v171
    v_lshlrev_b32 v192, 16, v172
    v_and_b32 v193, 0xffff0000, v172
    v_lshlrev_b32 v194, 16, v173
    v_and_b32 v195, 0xffff0000, v173
    v_add_f32 v30, v176, v177
    v_add_f32 v31, v178, v179
    v_add_f32 v30, v30, v180
    v_add_f32 v31, v31, v181
    v_add_f32 v30, v30, v182
    v_add_f32 v31, v31, v183
    v_add_f32 v30, v30, v184
    v_add_f32 v31, v31, v185
    v_add_f32 v30, v30, v186
    v_add_f32 v31, v31, v187
    v_add_f32 v30, v30, v188
    v_add_f32 v31, v31, v189
    v_add_f32 v30, v30, v190
    v_add_f32 v31, v31, v191
    v_add_f32 v30, v30, v192
    v_add_f32 v31, v31, v193
    v_add_f32 v30, v30, v194
    v_add_f32 v31, v31, v195
    v_add_f32 v30, v30, v31
    s_nop 1
    v_add_f32_dpp v31, v30, v30 quad_perm:[1,0,3,2] row_mask:0xf bank_mask:0xf
    s_nop 1
    v_add_f32_dpp v30, v31, v31 quad_perm:[2,3,0,1] row_mask:0xf bank_mask:0xf
    s_nop 1
    v_add_f32_dpp v31, v30, v30 row_half_mirror row_mask:0xf bank_mask:0xf
    s_nop 1
    v_add_f32_dpp v30, v31, v31 row_mirror row_mask:0xf bank_mask:0xf
    v_mov_b32 v31, v30
    s_nop 1
    v_permlane16_swap_b32 v31, v30
    v_add_f32 v30, v31, v30
    v_mul_f32 v30, 0x3acccccd, v30
    v_sub_f32 v176, v176, v30
    v_sub_f32 v177, v177, v30
    v_sub_f32 v178, v178, v30
    v_sub_f32 v179, v179, v30
    v_sub_f32 v180, v180, v30
    v_sub_f32 v181, v181, v30
    v_sub_f32 v182, v182, v30
    v_sub_f32 v183, v183, v30
    v_sub_f32 v184, v184, v30
    v_sub_f32 v185, v185, v30
    v_sub_f32 v186, v186, v30
    v_sub_f32 v187, v187, v30
    v_sub_f32 v188, v188, v30
    v_sub_f32 v189, v189, v30
    v_sub_f32 v190, v190, v30
    v_sub_f32 v191, v191, v30
    v_sub_f32 v192, v192, v30
    v_sub_f32 v193, v193, v30
    v_sub_f32 v194, v194, v30
    v_sub_f32 v195, v195, v30
    v_mul_f32 v32, v176, v176
    v_mul_f32 v33, v177, v177
    v_fmac_f32 v32, v178, v178
    v_fmac_f32 v33, v179, v179
    v_fmac_f32 v32, v180, v180
    v_fmac_f32 v33, v181, v181
    v_fmac_f32 v32, v182, v182
    v_fmac_f32 v33, v183, v183
    v_fmac_f32 v32, v184, v184
    v_fmac_f32 v33, v185, v185
    v_fmac_f32 v32, v186, v186
    v_fmac_f32 v33, v187, v187
    v_fmac_f32 v32, v188, v188
    v_fmac_f32 v33, v189, v189
    v_fmac_f32 v32, v190, v190
    v_fmac_f32 v33, v191, v191
    v_fmac_f32 v32, v192, v192
    v_fmac_f32 v33, v193, v193
    v_fmac_f32 v32, v194, v194
    v_fmac_f32 v33, v195, v195
    v_add_f32 v32, v32, v33
    s_nop 1
    v_add_f32_dpp v33, v32, v32 quad_perm:[1,0,3,2] row_mask:0xf bank_mask:0xf
    s_nop 1
    v_add_f32_dpp v32, v33, v33 quad_perm:[2,3,0,1] row_mask:0xf bank_mask:0xf
    s_nop 1
    v_add_f32_dpp v33, v32, v32 row_half_mirror row_mask:0xf bank_mask:0xf
    s_nop 1
    v_add_f32_dpp v32, v33, v33 row_mirror row_mask:0xf bank_mask:0xf
    v_mov_b32 v33, v32
    s_nop 1
    v_permlane16_swap_b32 v33, v32
    v_add_f32 v32, v33, v32
    v_mov_b32 v33, 0x3727c5ac
    v_fmac_f32 v33, 0x3acccccd, v32
    v_rsq_f32 v33, v33
    v_lshrrev_b32 v34, 5, v0
    v_mul_u32_u24 v34, 2560, v34
    v_and_b32 v35, 31, v0
    v_mul_u32_u24 v35, 80, v35
    v_add_u32 v34, v34, v35
    v_add_u32 v34, 20480, v34
    v_mul_f32 v176, v176, v33
    v_mul_f32 v177, v177, v33
    v_mul_f32 v178, v178, v33
    v_mul_f32 v179, v179, v33
    v_mul_f32 v180, v180, v33
    v_mul_f32 v181, v181, v33
    v_mul_f32 v182, v182, v33
    v_mul_f32 v183, v183, v33
    v_mul_f32 v184, v184, v33
    v_mul_f32 v185, v185, v33
    v_mul_f32 v186, v186, v33
    v_mul_f32 v187, v187, v33
    v_mul_f32 v188, v188, v33
    v_mul_f32 v189, v189, v33
    v_mul_f32 v190, v190, v33
    v_mul_f32 v191, v191, v33
    v_mul_f32 v192, v192, v33
    v_mul_f32 v193, v193, v33
    v_mul_f32 v194, v194, v33
    v_mul_f32 v195, v195, v33
    v_cvt_pk_bf16_f32 v176, v176, v176
    v_cvt_pk_bf16_f32 v177, v177, v177
    v_cvt_pk_bf16_f32 v178, v178, v178
    v_cvt_pk_bf16_f32 v179, v179, v179
    v_cvt_pk_bf16_f32 v180, v180, v180
    v_cvt_pk_bf16_f32 v181, v181, v181
    v_cvt_pk_bf16_f32 v182, v182, v182
    v_cvt_pk_bf16_f32 v183, v183, v183
    v_cvt_pk_bf16_f32 v184, v184, v184
    v_cvt_pk_bf16_f32 v185, v185, v185
    v_cvt_pk_bf16_f32 v186, v186, v186
    v_cvt_pk_bf16_f32 v187, v187, v187
    v_cvt_pk_bf16_f32 v188, v188, v188
    v_cvt_pk_bf16_f32 v189, v189, v189
    v_cvt_pk_bf16_f32 v190, v190, v190
    v_cvt_pk_bf16_f32 v191, v191, v191
    v_cvt_pk_bf16_f32 v192, v192, v192
    v_cvt_pk_bf16_f32 v193, v193, v193
    v_cvt_pk_bf16_f32 v194, v194, v194
    v_cvt_pk_bf16_f32 v195, v195, v195
    ds_write_b128 v34, v[176:179] offset:0
    ds_write_b128 v34, v[180:183] offset:16
    ds_write_b128 v34, v[184:187] offset:32
    ds_write_b128 v34, v[188:191] offset:48
    ds_write_b128 v34, v[192:195] offset:64
    s_mul_i32 s54, s50, 1179648
    s_mul_i32 s55, s48, 98304
    s_add_u32 s54, s54, s55
    s_mul_i32 s55, s49, 384
    s_add_u32 s59, s54, s55
    buffer_load_dwordx4 v[128:131], v8, s[12:15], s59 offen offset:0
    buffer_load_dwordx4 v[132:135], v8, s[12:15], s59 offen offset:128
    buffer_load_dwordx4 v[136:139], v8, s[12:15], s59 offen offset:256
    s_add_u32 s59, s59, 393216
    buffer_load_dwordx4 v[140:143], v8, s[12:15], s59 offen offset:0
    buffer_load_dwordx4 v[144:147], v8, s[12:15], s59 offen offset:128
    buffer_load_dwordx4 v[148:151], v8, s[12:15], s59 offen offset:256
    s_add_u32 s59, s59, 393216
    buffer_load_dwordx4 v[152:155], v8, s[12:15], s59 offen offset:0
    buffer_load_dwordx4 v[156:159], v8, s[12:15], s59 offen offset:128
    buffer_load_dwordx4 v[160:163], v8, s[12:15], s59 offen offset:256
    s_waitcnt vmcnt(17)
    v_readfirstlane_b32 s53, v1
    s_nop 0
    s_or_b32 s53, s53, 0x4000400f
    s_add_u32 s53, s53, 1
    s_andn2_b32 s53, s53, 0x4000400f
    s_getreg_b32 s40, hwreg(HW_REG_XCC_ID, 0, 4)
    s_or_b32 s40, s40, s53
    v_mov_b32 v1, s53
    s_mul_i32 s54, s50, 80
    s_mul_i32 s55, s48, 20
    s_add_u32 s54, s54, s55
    s_lshl_b32 s54, s54, 2
    s_add_u32 s54, s54, 20480
    v_add_u32 v30, s54, v18
    s_waitcnt lgkmcnt(0)
    ds_read_b32 v31, v30 offset:0
    ds_read_b32 v32, v30 offset:16
    ds_read_b32 v33, v30 offset:32
    ds_read_b32 v34, v30 offset:48
    ds_read_b32 v35, v30 offset:64
    v_min_u32 v248, 95, v14
    v_lshrrev_b32 v36, 4, v248
    v_xor_b32 v248, v248, v36
    v_lshlrev_b32 v248, 4, v248
    v_lshlrev_b32 v249, 4, v14
    v_mov_b32 v36, 2130706432
    v_cmp_gt_u32 vcc, 96, v14
    s_nop 1
    v_cndmask_b32 v249, v36, v249, vcc
    v_lshlrev_b32 v59, 4, v12
    v_xor_b32 v58, v59, v19
    v_xor_b32 v59, 64, v58
    s_add_u32 s56, s68, 524288
    s_waitcnt lgkmcnt(0)
    v_and_b32 v36, v31, v2
    v_and_b32 v37, v31, v3
    v_and_b32 v38, v31, v4
    v_and_b32 v39, v31, v5
    v_and_b32 v40, v32, v2
    v_and_b32 v41, v32, v3
    v_and_b32 v42, v32, v4
    v_and_b32 v43, v32, v5
    v_and_b32 v44, v33, v2
    v_and_b32 v45, v33, v3
    v_and_b32 v46, v33, v4
    v_and_b32 v47, v33, v5
    v_and_b32 v48, v34, v2
    v_and_b32 v49, v34, v3
    v_and_b32 v50, v34, v4
    v_and_b32 v51, v34, v5
    v_and_b32 v52, v35, v2
    v_and_b32 v53, v35, v3
    v_and_b32 v54, v35, v4
    v_and_b32 v55, v35, v5
    s_waitcnt vmcnt(9)
    v_mfma_f32_16x16x32_bf16 v[224:227], a[0:3], v[36:39], 0
    v_mfma_f32_16x16x32_bf16 v[228:231], a[20:23], v[36:39], 0
    v_mfma_f32_16x16x32_bf16 v[224:227], a[4:7], v[40:43], v[224:227]
    v_mfma_f32_16x16x32_bf16 v[232:235], a[20:23], v[40:43], 0
    v_mfma_f32_16x16x32_bf16 v[224:227], a[8:11], v[44:47], v[224:227]
    v_mfma_f32_16x16x32_bf16 v[228:231], a[24:27], v[44:47], v[228:231]
    v_mfma_f32_16x16x32_bf16 v[224:227], a[12:15], v[48:51], v[224:227]
    v_mfma_f32_16x16x32_bf16 v[232:235], a[24:27], v[48:51], v[232:235]
    v_mfma_f32_16x16x32_bf16 v[224:227], a[16:19], v[52:55], v[224:227]
    v_mfma_f32_16x16x32_bf16 v[228:231], a[28:31], v[52:55], v[228:231]
    s_nop 5
    v_mov_b32 v52, v232
    v_mov_b32 v53, v233
    v_mov_b32 v54, v234
    v_mov_b32 v55, v235
    v_permlane32_swap_b32 v52, v232
    v_permlane32_swap_b32 v53, v233
    v_permlane32_swap_b32 v54, v234
    v_permlane32_swap_b32 v55, v235
    v_add_f32 v228, v228, v232
    v_add_f32 v229, v229, v233
    v_add_f32 v230, v230, v234
    v_add_f32 v231, v231, v235
    ds_write_b128 v58, v[224:227]
    ds_write_b128 v59, v[228:231] offset:1024
    s_waitcnt lgkmcnt(0)
    s_barrier
    ds_read_b128 v[36:39], v248
    ds_read_b128 v[40:43], v248 offset:5120
    ds_read_b128 v[44:47], v248 offset:10240
    ds_read_b128 v[48:51], v248 offset:15360
    v_mov_b32 v59, s40
    s_waitcnt lgkmcnt(0)
    v_pk_add_f32 v[36:37], v[36:37], v[40:41]
    v_pk_add_f32 v[44:45], v[44:45], v[48:49]
    v_pk_add_f32 v[38:39], v[38:39], v[42:43]
    v_pk_add_f32 v[46:47], v[46:47], v[50:51]
    v_pk_add_f32 v[36:37], v[36:37], v[44:45]
    v_pk_add_f32 v[38:39], v[38:39], v[46:47]
    v_perm_b32 v56, v36, v39, s3
    v_perm_b32 v57, v37, v39, s4
    v_perm_b32 v58, v38, v39, s5
    buffer_store_dwordx4 v[56:59], v249, s[32:35], s68 offen
    v_lshrrev_b32 v30, 5, v0
    v_lshlrev_b32 v30, 11, v30
    v_and_b32 v31, 31, v0
    v_min_u32 v31, 23, v31
    v_lshl_add_u32 v30, v31, 4, v30
    s_add_u32 s95, s87, 0
    buffer_load_dwordx4 a[176:179], v10, s[28:31], s95 offen
    s_add_u32 s95, s87, 12288
    buffer_load_dwordx4 a[180:183], v10, s[28:31], s95 offen
    s_mul_i32 s96, s48, 12288
    s_add_u32 s96, s96, 107008
    s_mul_i32 s98, s48, 12288
    s_add_u32 s98, s98, 57856
    s_add_u32 m0, s96, 0
    s_add_u32 s95, s72, 0
    buffer_load_dwordx4 v23, s[16:19], s95 offen  lds
    s_add_u32 m0, s96, 1024
    s_add_u32 s95, s72, 0
    buffer_load_dwordx4 v24, s[16:19], s95 offen  lds
    s_mul_i32 s54, s48, 24
    v_add_u32 v31, s54, v31
    v_lshrrev_b32 v32, 4, v31
    v_lshlrev_b32 v32, 5, v32
    v_and_b32 v33, 7, v31
    v_add_u32 v32, v32, v33
    v_bfe_u32 v33, v31, 3, 1
    v_mul_u32_u24 v33, 192, v33
    v_add_lshl_u32 v32, v32, v33, 1
    v_add_u32 v32, 25600, v32
    v_and_b32 v33, 7, v0
    v_lshlrev_b32 v33, 4, v33
    v_add_u32 v33, 25600, v33
    s_lshl_b32 s54, s48, 7
    s_add_u32 s54, s54, 26368
    v_lshrrev_b32 v34, 3, v0
    v_lshlrev_b32 v34, 1, v34
    v_add_u32 v34, s54, v34
    v_and_b32 v35, 7, v0
    v_cmp_eq_u32 s[60:61], 0, v35
    v_bfe_u32 v35, v0, 2, 1
    v_lshlrev_b32 v35, 6, v35
    v_add_u32 v35, s54, v35
    v_and_b32 v36, 3, v0
    v_cmp_eq_u32 vcc, 3, v36
    v_lshlrev_b32 v37, 4, v36
    s_nop 0
    v_cndmask_b32 v37, v37, 12, vcc
    v_add_u32 v35, v35, v37
    v_mov_b32 v37, 4
    v_cndmask_b32 v37, v37, 16, vcc
    v_add_u32 v38, v35, v37
    v_add_u32 v39, v38, v37
    s_and_b32 s55, s50, 1
    s_mul_i32 s56, s55, 3
    s_add_u32 s55, s55, 6
    v_add_u32 v37, s56, v36
    v_mov_b32 v40, s55
    v_cndmask_b32 v37, v37, v40, vcc
    v_lshlrev_b32 v37, 10, v37
    v_bfe_u32 v40, v0, 2, 1
    v_lshl_add_u32 v37, v40, 16, v37
    v_mov_b32 v40, 2130706432
    v_cmp_gt_u32 vcc, 8, v0
    s_nop 1
    v_cndmask_b32 v37, v40, v37, vcc
    v_mov_b32 v224, 0
    v_mov_b32 v225, 0
    v_mov_b32 v226, 0
    v_mov_b32 v227, 0
    v_mov_b32 v228, 0
    v_mov_b32 v229, 0
    s_waitcnt vmcnt(10)
    s_waitcnt vmcnt(7)
    s_waitcnt vmcnt(5)
    v_lshlrev_b32 v15, 16, v15
    v_lshlrev_b32 v63, 16, v63
    v_add_f32 v15, v15, v63
    s_add_u32 s54, s69, 0
    buffer_load_dwordx4 v[64:67], v30, s[32:35], s54 offen sc1
    s_add_u32 s54, s69, 4096
    buffer_load_dwordx4 v[68:71], v30, s[32:35], s54 offen sc1
    s_add_u32 s54, s69, 8192
    buffer_load_dwordx4 v[72:75], v30, s[32:35], s54 offen sc1
    s_add_u32 s54, s69, 12288
    buffer_load_dwordx4 v[76:79], v30, s[32:35], s54 offen sc1
    s_mov_b32 s58, 0
    s_waitcnt vmcnt(0)
L_chk_A:
    v_and_b32 v44, 0xfffffff0, v67
    v_cmpx_eq_u32 vcc, s53, v44
    v_and_b32 v44, 0xfffffff0, v71
    v_cmpx_eq_u32 vcc, s53, v44
    v_and_b32 v44, 0xfffffff0, v75
    v_cmpx_eq_u32 vcc, s53, v44
    v_and_b32 v44, 0xfffffff0, v79
    v_cmpx_eq_u32 vcc, s53, v44
    s_nop 1
    s_cmp_eq_u64 exec, -1
    s_mov_b64 exec, -1
    s_cbranch_scc1 L_ok_A
    s_add_u32 s58, s58, 1
    s_cmp_gt_u32 s58, 40000
    s_cbranch_scc1 L_exit
    s_cmp_eq_u32 s58, 32
    s_cbranch_scc0 L_noy_A
    s_add_u32 s57, s68, 524288
    buffer_store_dwordx4 v[56:59], v249, s[32:35], s57 offen sc1
L_noy_A:
    s_cmp_ge_u32 s58, 40
    s_cselect_b32 s57, 524288, 0
    s_xor_b32 s69, s69, s57
    s_add_u32 s54, s69, 0
    buffer_load_dwordx4 v[64:67], v30, s[32:35], s54 offen sc1
    s_add_u32 s54, s69, 4096
    buffer_load_dwordx4 v[68:71], v30, s[32:35], s54 offen sc1
    s_add_u32 s54, s69, 8192
    buffer_load_dwordx4 v[72:75], v30, s[32:35], s54 offen sc1
    s_add_u32 s54, s69, 12288
    buffer_load_dwordx4 v[76:79], v30, s[32:35], s54 offen sc1
    s_waitcnt vmcnt(0)
    s_branch L_chk_A
L_ok_A:
    v_cmpx_eq_u32 vcc, s40, v67
    v_cmpx_eq_u32 vcc, s40, v71
    v_cmpx_eq_u32 vcc, s40, v75
    v_cmpx_eq_u32 vcc, s40, v79
    s_nop 1
    s_cmp_eq_u64 exec, -1
    s_mov_b64 exec, -1
    s_cselect_b32 s41, 1, 0
    s_cbranch_scc1 L_coloc
    s_add_u32 s57, s68, 524288
    buffer_store_dwordx4 v[56:59], v249, s[32:35], s57 offen sc1
    s_add_u32 s74, s74, 1048576
    s_add_u32 s75, s75, 1048576
    s_add_u32 s83, s83, 524288
    s_add_u32 s84, s84, 524288
L_coloc:
    v_perm_b32 v44, v64, v65, s6
    v_perm_b32 v67, v44, v66, s7
    v_perm_b32 v45, v68, v69, s6
    v_perm_b32 v71, v45, v70, s7
    v_perm_b32 v46, v72, v73, s6
    v_perm_b32 v75, v46, v74, s7
    v_perm_b32 v47, v76, v77, s6
    v_perm_b32 v79, v47, v78, s7
    v_add_f32 v64, v64, v68
    v_add_f32 v72, v72, v76
    v_add_f32 v65, v65, v69
    v_add_f32 v73, v73, v77
    v_add_f32 v66, v66, v70
    v_add_f32 v74, v74, v78
    v_add_f32 v67, v67, v71
    v_add_f32 v75, v75, v79
    v_add_f32 v64, v64, v72
    v_add_f32 v65, v65, v73
    v_add_f32 v66, v66, v74
    v_add_f32 v67, v67, v75
    v_mov_b32 v44, v64
    v_mov_b32 v45, v65
    v_mov_b32 v46, v66
    v_mov_b32 v47, v67
    v_permlane32_swap_b32 v44, v64
    v_permlane32_swap_b32 v45, v65
    v_permlane32_swap_b32 v46, v66
    v_permlane32_swap_b32 v47, v67
    v_add_f32 v64, v44, v64
    v_add_f32 v65, v45, v65
    v_add_f32 v66, v46, v66
    v_add_f32 v67, v47, v67
    v_cvt_pk_bf16_f32 v64, v64, v65
    v_cvt_pk_bf16_f32 v65, v66, v67
    ds_write_b16 v32, v64
    ds_write_b16_d16_hi v32, v64 offset:16
    ds_write_b16 v32, v65 offset:32
    ds_write_b16_d16_hi v32, v65 offset:48
    s_waitcnt lgkmcnt(0)
    s_barrier
    s_add_u32 m0, s96, 2048
    s_add_u32 s95, s72, 0
    buffer_load_dwordx4 v25, s[16:19], s95 offen  lds
    s_add_u32 m0, s98, 0
    s_add_u32 s95, s73, 0
    buffer_load_dwordx4 v20, s[16:19], s95 offen  lds
    s_add_u32 m0, s98, 1024
    s_add_u32 s95, s73, 0
    buffer_load_dwordx4 v21, s[16:19], s95 offen  lds
    ds_read_b128 v[176:179], v33 offset:0
    ds_read_b128 v[180:183], v33 offset:128
    ds_read_b128 v[184:187], v33 offset:256
    ds_read_b128 v[188:191], v33 offset:384
    ds_read_b128 v[192:195], v33 offset:512
    ds_read_b128 v[196:199], v33 offset:640
    s_waitcnt lgkmcnt(0)
    s_add_u32 m0, s98, 2048
    s_add_u32 s95, s73, 0
    buffer_load_dwordx4 v22, s[16:19], s95 offen  lds
    v_dot2c_f32_bf16 v224, v128, v176
    v_dot2c_f32_bf16 v225, v128, v188
    v_dot2c_f32_bf16 v224, v129, v177
    v_dot2c_f32_bf16 v225, v129, v189
    v_dot2c_f32_bf16 v224, v130, v178
    v_dot2c_f32_bf16 v225, v130, v190
    v_dot2c_f32_bf16 v224, v131, v179
    v_dot2c_f32_bf16 v225, v131, v191
    v_dot2c_f32_bf16 v224, v132, v180
    v_dot2c_f32_bf16 v225, v132, v192
    v_dot2c_f32_bf16 v224, v133, v181
    v_dot2c_f32_bf16 v225, v133, v193
    v_dot2c_f32_bf16 v224, v134, v182
    v_dot2c_f32_bf16 v225, v134, v194
    v_dot2c_f32_bf16 v224, v135, v183
    v_dot2c_f32_bf16 v225, v135, v195
    v_dot2c_f32_bf16 v224, v136, v184
    v_dot2c_f32_bf16 v225, v136, v196
    v_dot2c_f32_bf16 v224, v137, v185
    v_dot2c_f32_bf16 v225, v137, v197
    v_dot2c_f32_bf16 v224, v138, v186
    v_dot2c_f32_bf16 v225, v138, v198
    v_dot2c_f32_bf16 v224, v139, v187
    v_dot2c_f32_bf16 v225, v139, v199
    s_add_u32 m0, s96, 3072
    s_add_u32 s95, s72, 12288
    buffer_load_dwordx4 v26, s[16:19], s95 offen  lds
    v_dot2c_f32_bf16 v226, v140, v176
    v_dot2c_f32_bf16 v227, v140, v188
    v_dot2c_f32_bf16 v226, v141, v177
    v_dot2c_f32_bf16 v227, v141, v189
    v_dot2c_f32_bf16 v226, v142, v178
    v_dot2c_f32_bf16 v227, v142, v190
    v_dot2c_f32_bf16 v226, v143, v179
    v_dot2c_f32_bf16 v227, v143, v191
    v_dot2c_f32_bf16 v226, v144, v180
    v_dot2c_f32_bf16 v227, v144, v192
    v_dot2c_f32_bf16 v226, v145, v181
    v_dot2c_f32_bf16 v227, v145, v193
    v_dot2c_f32_bf16 v226, v146, v182
    v_dot2c_f32_bf16 v227, v146, v194
    v_dot2c_f32_bf16 v226, v147, v183
    v_dot2c_f32_bf16 v227, v147, v195
    v_dot2c_f32_bf16 v226, v148, v184
    v_dot2c_f32_bf16 v227, v148, v196
    v_dot2c_f32_bf16 v226, v149, v185
    v_dot2c_f32_bf16 v227, v149, v197
    v_dot2c_f32_bf16 v226, v150, v186
    v_dot2c_f32_bf16 v227, v150, v198
    v_dot2c_f32_bf16 v226, v151, v187
    v_dot2c_f32_bf16 v227, v151, v199
    s_add_u32 m0, s96, 4096
    s_add_u32 s95, s72, 12288
    buffer_load_dwordx4 v27, s[16:19], s95 offen  lds
    v_dot2c_f32_bf16 v228, v152, v176
    v_dot2c_f32_bf16 v229, v152, v188
    v_dot2c_f32_bf16 v228, v153, v177
    v_dot2c_f32_bf16 v229, v153, v189
    v_dot2c_f32_bf16 v228, v154, v178
    v_dot2c_f32_bf16 v229, v154, v190
    v_dot2c_f32_bf16 v228, v155, v179
    v_dot2c_f32_bf16 v229, v155, v191
    v_dot2c_f32_bf16 v228, v156, v180
    v_dot2c_f32_bf16 v229, v156, v192
    v_dot2c_f32_bf16 v228, v157, v181
    v_dot2c_f32_bf16 v229, v157, v193
    v_dot2c_f32_bf16 v228, v158, v182
    v_dot2c_f32_bf16 v229, v158, v194
    v_dot2c_f32_bf16 v228, v159, v183
    v_dot2c_f32_bf16 v229, v159, v195
    v_dot2c_f32_bf16 v228, v160, v184
    v_dot2c_f32_bf16 v229, v160, v196
    v_dot2c_f32_bf16 v228, v161, v185
    v_dot2c_f32_bf16 v229, v161, v197
    v_dot2c_f32_bf16 v228, v162, v186
    v_dot2c_f32_bf16 v229, v162, v198
    v_dot2c_f32_bf16 v228, v163, v187
    v_dot2c_f32_bf16 v229, v163, v199
    v_add_f32_dpp v224, v224, v224 quad_perm:[1,0,3,2] row_mask:0xf bank_mask:0xf
    v_add_f32_dpp v225, v225, v225 quad_perm:[1,0,3,2] row_mask:0xf bank_mask:0xf
    v_add_f32_dpp v226, v226, v226 quad_perm:[1,0,3,2] row_mask:0xf bank_mask:0xf
    v_add_f32_dpp v227, v227, v227 quad_perm:[1,0,3,2] row_mask:0xf bank_mask:0xf
    v_add_f32_dpp v228, v228, v228 quad_perm:[1,0,3,2] row_mask:0xf bank_mask:0xf
    v_add_f32_dpp v229, v229, v229 quad_perm:[1,0,3,2] row_mask:0xf bank_mask:0xf
    v_add_f32_dpp v224, v224, v224 quad_perm:[2,3,0,1] row_mask:0xf bank_mask:0xf
    v_add_f32_dpp v225, v225, v225 quad_perm:[2,3,0,1] row_mask:0xf bank_mask:0xf
    v_add_f32_dpp v226, v226, v226 quad_perm:[2,3,0,1] row_mask:0xf bank_mask:0xf
    v_add_f32_dpp v227, v227, v227 quad_perm:[2,3,0,1] row_mask:0xf bank_mask:0xf
    v_add_f32_dpp v228, v228, v228 quad_perm:[2,3,0,1] row_mask:0xf bank_mask:0xf
    v_add_f32_dpp v229, v229, v229 quad_perm:[2,3,0,1] row_mask:0xf bank_mask:0xf
    v_add_f32_dpp v224, v224, v224 row_half_mirror row_mask:0xf bank_mask:0xf
    v_add_f32_dpp v225, v225, v225 row_half_mirror row_mask:0xf bank_mask:0xf
    v_add_f32_dpp v226, v226, v226 row_half_mirror row_mask:0xf bank_mask:0xf
    v_add_f32_dpp v227, v227, v227 row_half_mirror row_mask:0xf bank_mask:0xf
    v_add_f32_dpp v228, v228, v228 row_half_mirror row_mask:0xf bank_mask:0xf
    v_add_f32_dpp v229, v229, v229 row_half_mirror row_mask:0xf bank_mask:0xf
    v_cvt_pk_bf16_f32 v44, v224, v225
    v_cvt_pk_bf16_f32 v45, v226, v227
    v_cvt_pk_bf16_f32 v46, v228, v229
    s_mov_b64 exec, s[60:61]
    ds_write_b16 v34, v44 offset:0
    ds_write_b16_d16_hi v34, v44 offset:64
    ds_write_b16 v34, v45 offset:16
    ds_write_b16_d16_hi v34, v45 offset:80
    ds_write_b16 v34, v46 offset:32
    ds_write_b16_d16_hi v34, v46 offset:96
    s_mov_b64 exec, -1
    v_mov_b32 v51, v1
    s_waitcnt lgkmcnt(0)
    ds_read_b32 v48, v35
    ds_read_b32 v49, v38
    ds_read_b32 v50, v39
    s_waitcnt lgkmcnt(0)
    buffer_store_dwordx4 v[48:51], v37, s[32:35], s70 offen sc1
    s_waitcnt vmcnt(30)
    s_add_u32 m0, s96, 5120
    s_add_u32 s95, s72, 12288
    buffer_load_dwordx4 v28, s[16:19], s95 offen  lds
    s_waitcnt vmcnt(30)
    s_add_u32 m0, s98, 3072
    s_add_u32 s95, s73, 12288
    buffer_load_dwordx4 v20, s[16:19], s95 offen  lds
    s_waitcnt vmcnt(30)
    s_add_u32 m0, s98, 4096
    s_add_u32 s95, s73, 12288
    buffer_load_dwordx4 v21, s[16:19], s95 offen  lds
    s_waitcnt vmcnt(30)
    s_add_u32 m0, s98, 5120
    s_add_u32 s95, s73, 12288
    buffer_load_dwordx4 v22, s[16:19], s95 offen  lds
    s_waitcnt vmcnt(30)
    s_add_u32 m0, s96, 6144
    s_add_u32 s95, s72, 24576
    buffer_load_dwordx4 v23, s[16:19], s95 offen  lds
    s_waitcnt vmcnt(30)
    s_add_u32 m0, s96, 7168
    s_add_u32 s95, s72, 24576
    buffer_load_dwordx4 v24, s[16:19], s95 offen  lds
    s_waitcnt vmcnt(30)
    s_add_u32 m0, s96, 8192
    s_add_u32 s95, s72, 24576
    buffer_load_dwordx4 v25, s[16:19], s95 offen  lds
    s_waitcnt vmcnt(30)
    s_add_u32 m0, s98, 6144
    s_add_u32 s95, s73, 24576
    buffer_load_dwordx4 v20, s[16:19], s95 offen  lds
    s_waitcnt vmcnt(30)
    s_add_u32 m0, s98, 7168
    s_add_u32 s95, s73, 24576
    buffer_load_dwordx4 v21, s[16:19], s95 offen  lds
    s_waitcnt vmcnt(30)
    s_add_u32 m0, s98, 8192
    s_add_u32 s95, s73, 24576
    buffer_load_dwordx4 v22, s[16:19], s95 offen  lds
    s_waitcnt vmcnt(30)
    s_add_u32 m0, s96, 9216
    s_add_u32 s95, s72, 36864
    buffer_load_dwordx4 v26, s[16:19], s95 offen  lds
    s_waitcnt vmcnt(30)
    s_add_u32 m0, s96, 10240
    s_add_u32 s95, s72, 36864
    buffer_load_dwordx4 v27, s[16:19], s95 offen  lds
    s_waitcnt vmcnt(30)
    s_add_u32 m0, s96, 11264
    s_add_u32 s95, s72, 36864
    buffer_load_dwordx4 v28, s[16:19], s95 offen  lds
    s_waitcnt vmcnt(30)
    s_add_u32 m0, s98, 9216
    s_add_u32 s95, s73, 36864
    buffer_load_dwordx4 v20, s[16:19], s95 offen  lds
    s_waitcnt vmcnt(30)
    s_add_u32 m0, s98, 10240
    s_add_u32 s95, s73, 36864
    buffer_load_dwordx4 v21, s[16:19], s95 offen  lds
    s_waitcnt vmcnt(30)
    s_add_u32 m0, s98, 11264
    s_add_u32 s95, s73, 36864
    buffer_load_dwordx4 v22, s[16:19], s95 offen  lds
    buffer_load_dwordx4 v[64:67], v11, s[32:35], s71 offen offset:0 sc1
    buffer_load_dwordx4 v[68:71], v11, s[32:35], s71 offen offset:1024 sc1
    buffer_load_dwordx4 v[72:75], v11, s[32:35], s71 offen offset:2048 sc1
    buffer_load_dwordx4 v[76:79], v11, s[32:35], s71 offen offset:3072 sc1
    s_add_u32 s54, s71, 4096
    buffer_load_dwordx4 v[80:83], v11, s[32:35], s54 offen offset:0 sc1
    buffer_load_dwordx4 v[84:87], v11, s[32:35], s54 offen offset:1024 sc1
    buffer_load_dwordx4 v[88:91], v11, s[32:35], s54 offen offset:2048 sc1
    buffer_load_dwordx4 v[92:95], v11, s[32:35], s54 offen offset:3072 sc1
    s_add_u32 s54, s71, 8192
    buffer_load_dwordx4 v[96:99], v11, s[32:35], s54 offen offset:0 sc1
    buffer_load_dwordx4 v[100:103], v11, s[32:35], s54 offen offset:1024 sc1
    buffer_load_dwordx4 v[104:107], v11, s[32:35], s54 offen offset:2048 sc1
    buffer_load_dwordx4 v[108:111], v11, s[32:35], s54 offen offset:3072 sc1
    s_add_u32 s54, s71, 12288
    buffer_load_dwordx4 v[112:115], v11, s[32:35], s54 offen offset:0 sc1
    buffer_load_dwordx4 v[116:119], v11, s[32:35], s54 offen offset:1024 sc1
    buffer_load_dwordx4 v[120:123], v11, s[32:35], s54 offen offset:2048 sc1
    buffer_load_dwordx4 v[124:127], v11, s[32:35], s54 offen offset:3072 sc1
    v_add_u32 v33, s88, v18
    ds_read_b32 v34, v33
    ds_read_b32 v35, v33 offset:16
    s_waitcnt vmcnt(45) lgkmcnt(0)
    v_and_b32 v36, v34, v2
    v_and_b32 v37, v34, v3
    v_and_b32 v38, v34, v4
    v_and_b32 v39, v34, v5
    v_and_b32 v40, v35, v2
    v_and_b32 v41, v35, v3
    v_and_b32 v42, v35, v4
    v_and_b32 v43, v35, v5
    v_mfma_f32_16x16x32_bf16 v[224:227], a[176:179], v[36:39], 0
    s_nop 0
    v_mfma_f32_16x16x32_bf16 v[224:227], a[180:183], v[40:43], v[224:227]
    s_nop 7
    ds_write_b128 v19, v[224:227] offset:4096
    v_min_u32 v30, 63, v14
    v_and_b32 v31, 48, v30
    v_and_b32 v32, 1, v30
    v_lshl_add_u32 v31, v32, 3, v31
    v_bfe_u32 v32, v30, 2, 2
    v_lshl_add_u32 v31, v32, 1, v31
    v_bfe_u32 v32, v30, 1, 1
    v_add_u32 v31, v31, v32
    v_lshlrev_b32 v31, 4, v31
    v_add_u32 v31, 4096, v31
    s_waitcnt lgkmcnt(0)
    s_barrier
    ds_read_b128 v[36:39], v31
    ds_read_b128 v[40:43], v31 offset:5120
    ds_read_b128 v[44:47], v31 offset:10240
    ds_read_b128 v[48:51], v31 offset:15360
    v_lshlrev_b32 v30, 4, v14
    v_mov_b32 v31, 2130706432
    v_cmp_gt_u32 vcc, 64, v14
    s_nop 1
    v_cndmask_b32 v30, v31, v30, vcc
    v_mov_b32 v35, v1
    s_waitcnt lgkmcnt(0)
    v_pk_add_f32 v[36:37], v[36:37], v[40:41]
    v_pk_add_f32 v[44:45], v[44:45], v[48:49]
    v_pk_add_f32 v[38:39], v[38:39], v[42:43]
    v_pk_add_f32 v[46:47], v[46:47], v[50:51]
    v_pk_add_f32 v[36:37], v[36:37], v[44:45]
    v_pk_add_f32 v[38:39], v[38:39], v[46:47]
    v_perm_b32 v32, v36, v39, s3
    v_perm_b32 v33, v37, v39, s4
    v_perm_b32 v34, v38, v39, s5
    buffer_store_dwordx4 v[32:35], v30, s[32:35], s78 offen sc1
    s_nop 1
    v_mul_u32_u24 v30, 384, v13
    s_mul_i32 s54, s48, 12288
    s_add_u32 s54, s54, 107008
    v_add_u32 v30, s54, v30
    v_bfe_u32 v31, v13, 1, 3
    v_xor_b32 v31, v31, v12
    v_lshl_add_u32 v30, v31, 4, v30
    v_xor_b32 v31, 64, v30
    s_waitcnt vmcnt(20)
    ds_read_b128 a[40:43], v30 offset:0
    ds_read_b128 a[44:47], v31 offset:0
    ds_read_b128 a[48:51], v30 offset:128
    ds_read_b128 a[52:55], v31 offset:128
    ds_read_b128 a[56:59], v30 offset:256
    ds_read_b128 a[60:63], v31 offset:256
    ds_read_b128 a[64:67], v30 offset:6144
    ds_read_b128 a[68:71], v31 offset:6144
    ds_read_b128 a[72:75], v30 offset:6272
    ds_read_b128 a[76:79], v31 offset:6272
    ds_read_b128 a[80:83], v30 offset:6400
    ds_read_b128 a[84:87], v31 offset:6400
    v_mul_u32_u24 v6, 49152, v12
    v_and_b32 v29, 7, v13
    v_lshl_add_u32 v7, v29, 4, v6
    v_lshrrev_b32 v29, 3, v13
    v_mul_u32_u24 v29, 12288, v29
    v_add_u32 v7, v7, v29
    v_add_u32 v7, 256, v7
    v_lshl_add_u32 v6, v13, 4, v6
    s_and_b32 s95, s48, 1
    s_mul_i32 s95, s95, 221184
    s_add_u32 s95, s95, s79
    s_add_u32 s97, s95, 0
    buffer_load_dwordx4 a[88:91], v6, s[20:23], s97 offen
    buffer_load_dwordx4 a[112:115], v7, s[20:23], s97 offen
    s_and_b32 s95, s48, 1
    s_mul_i32 s95, s95, 221184
    s_add_u32 s95, s95, s79
    s_add_u32 s97, s95, 12288
    buffer_load_dwordx4 a[92:95], v6, s[20:23], s97 offen
    s_and_b32 s95, s48, 1
    s_mul_i32 s95, s95, 368640
    s_add_u32 s95, s95, s79
    s_add_u32 s97, s95, 24576
    buffer_load_dwordx4 a[96:99], v6, s[20:23], s97 offen
    buffer_load_dwordx4 a[116:119], v7, s[20:23], s97 offen
    s_and_b32 s95, s48, 1
    s_mul_i32 s95, s95, 368640
    s_add_u32 s95, s95, s79
    s_add_u32 s97, s95, 36864
    buffer_load_dwordx4 a[100:103], v6, s[20:23], s97 offen
    s_lshl_b32 s54, s48, 12
    s_add_u32 s54, s54, 31232
    v_add_u32 v32, s54, v11
    s_lshl_b32 s54, s48, 10
    s_add_u32 s54, s54, 31232
    v_add_u32 v33, s54, v11
    v_lshrrev_b32 v34, 1, v12
    v_lshlrev_b32 v34, 5, v34
    v_and_b32 v35, 1, v12
    v_lshl_add_u32 v34, v35, 2, v34
    v_lshrrev_b32 v36, 2, v13
    v_add_u32 v34, v34, v36
    v_mul_u32_u24 v34, 192, v34
    v_bfe_u32 v36, v13, 1, 1
    v_lshl_or_b32 v36, v35, 1, v36
    v_lshl_add_u32 v34, v36, 4, v34
    v_and_b32 v36, 1, v13
    v_lshl_add_u32 v34, v36, 3, v34
    s_lshr_b32 s54, s48, 1
    s_mul_i32 s54, s54, 24576
    s_add_u32 s54, s54, 57856
    v_add_u32 v250, s54, v34
    v_xor_b32 v251, 32, v250
    v_lshrrev_b32 v252, 5, v0
    v_lshlrev_b32 v252, 10, v252
    v_and_b32 v34, 31, v0
    v_lshl_add_u32 v252, v34, 4, v252
    s_mov_b32 s56, 0x3dd53b95
    s_add_u32 s55, s74, 1048576
    v_cmp_gt_u32 s[60:61], 32, v0
    s_mov_b32 s58, 0
    s_waitcnt vmcnt(7)
L_chk_B:
    v_cmpx_eq_u32 vcc, s53, v67
    v_cmpx_eq_u32 vcc, s53, v71
    v_cmpx_eq_u32 vcc, s53, v75
    v_cmpx_eq_u32 vcc, s53, v79
    v_cmpx_eq_u32 vcc, s53, v83
    v_cmpx_eq_u32 vcc, s53, v87
    v_cmpx_eq_u32 vcc, s53, v91
    v_cmpx_eq_u32 vcc, s53, v95
    v_cmpx_eq_u32 vcc, s53, v99
    v_cmpx_eq_u32 vcc, s53, v103
    v_cmpx_eq_u32 vcc, s53, v107
    v_cmpx_eq_u32 vcc, s53, v111
    v_cmpx_eq_u32 vcc, s53, v115
    v_cmpx_eq_u32 vcc, s53, v119
    v_cmpx_eq_u32 vcc, s53, v123
    v_cmpx_eq_u32 vcc, s53, v127
    s_nop 1
    s_cmp_eq_u64 exec, -1
    s_mov_b64 exec, -1
    s_cbranch_scc1 L_ok_B
    s_add_u32 s58, s58, 1
    s_cmp_gt_u32 s58, 40000
    s_cbranch_scc1 L_exit
    buffer_load_dwordx4 v[64:67], v11, s[32:35], s71 offen offset:0 sc1
    buffer_load_dwordx4 v[68:71], v11, s[32:35], s71 offen offset:1024 sc1
    buffer_load_dwordx4 v[72:75], v11, s[32:35], s71 offen offset:2048 sc1
    buffer_load_dwordx4 v[76:79], v11, s[32:35], s71 offen offset:3072 sc1
    s_add_u32 s54, s71, 4096
    buffer_load_dwordx4 v[80:83], v11, s[32:35], s54 offen offset:0 sc1
    buffer_load_dwordx4 v[84:87], v11, s[32:35], s54 offen offset:1024 sc1
    buffer_load_dwordx4 v[88:91], v11, s[32:35], s54 offen offset:2048 sc1
    buffer_load_dwordx4 v[92:95], v11, s[32:35], s54 offen offset:3072 sc1
    s_add_u32 s54, s71, 8192
    buffer_load_dwordx4 v[96:99], v11, s[32:35], s54 offen offset:0 sc1
    buffer_load_dwordx4 v[100:103], v11, s[32:35], s54 offen offset:1024 sc1
    buffer_load_dwordx4 v[104:107], v11, s[32:35], s54 offen offset:2048 sc1
    buffer_load_dwordx4 v[108:111], v11, s[32:35], s54 offen offset:3072 sc1
    s_add_u32 s54, s71, 12288
    buffer_load_dwordx4 v[112:115], v11, s[32:35], s54 offen offset:0 sc1
    buffer_load_dwordx4 v[116:119], v11, s[32:35], s54 offen offset:1024 sc1
    buffer_load_dwordx4 v[120:123], v11, s[32:35], s54 offen offset:2048 sc1
    buffer_load_dwordx4 v[124:127], v11, s[32:35], s54 offen offset:3072 sc1
    s_waitcnt vmcnt(0)
    s_branch L_chk_B
L_ok_B:
    v_mov_b32 v67, v88
    v_mov_b32 v71, v89
    v_mov_b32 v75, v90
    v_mov_b32 v79, v92
    v_mov_b32 v83, v93
    v_mov_b32 v87, v94
    v_mov_b32 v99, v120
    v_mov_b32 v103, v121
    v_mov_b32 v107, v122
    v_mov_b32 v111, v124
    v_mov_b32 v115, v125
    v_mov_b32 v119, v126
    s_waitcnt lgkmcnt(0)
    v_mfma_f32_16x16x32_bf16 v[224:227], a[40:43], v[64:67], 0
    v_mfma_f32_16x16x32_bf16 v[228:231], a[40:43], v[96:99], 0
    v_mfma_f32_16x16x32_bf16 v[232:235], a[64:67], v[64:67], 0
    v_mfma_f32_16x16x32_bf16 v[236:239], a[64:67], v[96:99], 0
    v_mfma_f32_16x16x32_bf16 v[224:227], a[44:47], v[68:71], v[224:227]
    v_mfma_f32_16x16x32_bf16 v[228:231], a[44:47], v[100:103], v[228:231]
    v_mfma_f32_16x16x32_bf16 v[232:235], a[68:71], v[68:71], v[232:235]
    v_mfma_f32_16x16x32_bf16 v[236:239], a[68:71], v[100:103], v[236:239]
    v_mfma_f32_16x16x32_bf16 v[224:227], a[48:51], v[72:75], v[224:227]
    v_mfma_f32_16x16x32_bf16 v[228:231], a[48:51], v[104:107], v[228:231]
    v_mfma_f32_16x16x32_bf16 v[232:235], a[72:75], v[72:75], v[232:235]
    v_mfma_f32_16x16x32_bf16 v[236:239], a[72:75], v[104:107], v[236:239]
    v_mfma_f32_16x16x32_bf16 v[224:227], a[52:55], v[76:79], v[224:227]
    v_mfma_f32_16x16x32_bf16 v[228:231], a[52:55], v[108:111], v[228:231]
    v_mfma_f32_16x16x32_bf16 v[232:235], a[76:79], v[76:79], v[232:235]
    v_mfma_f32_16x16x32_bf16 v[236:239], a[76:79], v[108:111], v[236:239]
    v_mfma_f32_16x16x32_bf16 v[224:227], a[56:59], v[80:83], v[224:227]
    v_mfma_f32_16x16x32_bf16 v[228:231], a[56:59], v[112:115], v[228:231]
    v_mfma_f32_16x16x32_bf16 v[232:235], a[80:83], v[80:83], v[232:235]
    v_mfma_f32_16x16x32_bf16 v[236:239], a[80:83], v[112:115], v[236:239]
    v_mfma_f32_16x16x32_bf16 v[224:227], a[60:63], v[84:87], v[224:227]
    v_mfma_f32_16x16x32_bf16 v[228:231], a[60:63], v[116:119], v[228:231]
    v_mfma_f32_16x16x32_bf16 v[232:235], a[84:87], v[84:87], v[232:235]
    v_mfma_f32_16x16x32_bf16 v[236:239], a[84:87], v[116:119], v[236:239]
    s_nop 4
    ds_write_b128 v32, v[224:227] offset:0
    ds_write_b128 v32, v[228:231] offset:1024
    ds_write_b128 v32, v[232:235] offset:2048
    ds_write_b128 v32, v[236:239] offset:3072
    s_waitcnt vmcnt(23)
    s_waitcnt lgkmcnt(0)
    s_barrier
    ds_read_b128 v[36:39], v33 offset:0
    ds_read_b128 v[40:43], v33 offset:4096
    ds_read_b128 v[44:47], v33 offset:8192
    ds_read_b128 v[48:51], v33 offset:12288
    v_mov_b32 v123, v1
    s_waitcnt lgkmcnt(0)
    v_pk_add_f32 v[36:37], v[36:37], v[40:41]
    v_pk_add_f32 v[44:45], v[44:45], v[48:49]
    v_pk_add_f32 v[38:39], v[38:39], v[42:43]
    v_pk_add_f32 v[46:47], v[46:47], v[50:51]
    v_pk_add_f32 v[36:37], v[36:37], v[44:45]
    v_pk_add_f32 v[38:39], v[38:39], v[46:47]
    v_max3_f32 v40, v36, v37, v38
    v_max_f32 v40, v40, v39
    v_mov_b32 v41, v40
    s_nop 1
    v_permlane16_swap_b32 v41, v40
    v_max_f32 v40, v41, v40
    v_mov_b32 v41, v40
    s_nop 1
    v_permlane32_swap_b32 v41, v40
    v_max_f32 v40, v41, v40
    v_mul_f32 v40, s56, v40
    v_ceil_f32 v40, v40
    v_fma_f32 v36, v36, s56, -v40
    v_fma_f32 v37, v37, s56, -v40
    v_fma_f32 v38, v38, s56, -v40
    v_fma_f32 v39, v39, s56, -v40
    v_exp_f32 v36, v36
    v_exp_f32 v37, v37
    v_exp_f32 v38, v38
    v_exp_f32 v39, v39
    v_add_f32 v41, v36, v37
    v_add_f32 v42, v38, v39
    v_cvt_pk_bf16_f32 v44, v36, v37
    v_cvt_pk_bf16_f32 v45, v38, v39
    v_add_f32 v41, v41, v42
    v_mov_b32 v46, v44
    v_mov_b32 v47, v44
    v_mov_b32 v42, v41
    s_nop 1
    v_permlane16_swap_b32 v42, v41
    v_add_f32 v41, v42, v41
    v_permlane32_swap_b32 v46, v47
    v_mov_b32 v42, v41
    s_nop 1
    v_permlane32_swap_b32 v42, v41
    v_add_f32 v41, v42, v41
    v_cndmask_b32 v120, v45, v44, s[60:61]
    v_cndmask_b32 v121, v40, v45, s[60:61]
    v_cndmask_b32 v122, v41, v47, s[60:61]
    s_cmp_eq_u32 s41, 0
    s_cbranch_scc1 L_wt1
    buffer_store_dwordx4 v[120:123], v11, s[32:35], s74 offen
    s_branch L_wd1
L_wt1:
    buffer_store_dwordx4 v[120:123], v11, s[32:35], s74 offen sc1
L_wd1:
    buffer_load_dwordx4 v[64:67], v252, s[32:35], s75 offen sc1
    buffer_load_dwordx4 v[80:83], v252, s[32:35], s75 offen offset:512 sc1
    s_add_u32 s54, s75, 4096
    buffer_load_dwordx4 v[68:71], v252, s[32:35], s54 offen sc1
    buffer_load_dwordx4 v[84:87], v252, s[32:35], s54 offen offset:512 sc1
    s_add_u32 s54, s75, 8192
    buffer_load_dwordx4 v[72:75], v252, s[32:35], s54 offen sc1
    buffer_load_dwordx4 v[88:91], v252, s[32:35], s54 offen offset:512 sc1
    s_add_u32 s54, s75, 12288
    buffer_load_dwordx4 v[76:79], v252, s[32:35], s54 offen sc1
    buffer_load_dwordx4 v[92:95], v252, s[32:35], s54 offen offset:512 sc1
    ds_read_b64_tr_b16 v[128:129], v250 offset:0
    ds_read_b64_tr_b16 v[130:131], v250 offset:3072
    ds_read_b64_tr_b16 v[132:133], v251 offset:0
    ds_read_b64_tr_b16 v[134:135], v251 offset:3072
    ds_read_b64_tr_b16 v[136:137], v250 offset:64
    ds_read_b64_tr_b16 v[138:139], v250 offset:3136
    ds_read_b64_tr_b16 v[140:141], v251 offset:64
    ds_read_b64_tr_b16 v[142:143], v251 offset:3136
    ds_read_b64_tr_b16 v[144:145], v250 offset:128
    ds_read_b64_tr_b16 v[146:147], v250 offset:3200
    ds_read_b64_tr_b16 v[148:149], v251 offset:128
    ds_read_b64_tr_b16 v[150:151], v251 offset:3200
    ds_read_b64_tr_b16 v[152:153], v250 offset:1536
    ds_read_b64_tr_b16 v[154:155], v250 offset:4608
    ds_read_b64_tr_b16 v[156:157], v251 offset:1536
    ds_read_b64_tr_b16 v[158:159], v251 offset:4608
    ds_read_b64_tr_b16 v[160:161], v250 offset:1600
    ds_read_b64_tr_b16 v[162:163], v250 offset:4672
    ds_read_b64_tr_b16 v[164:165], v251 offset:1600
    ds_read_b64_tr_b16 v[166:167], v251 offset:4672
    ds_read_b64_tr_b16 v[168:169], v250 offset:1664
    ds_read_b64_tr_b16 v[170:171], v250 offset:4736
    ds_read_b64_tr_b16 v[172:173], v251 offset:1664
    ds_read_b64_tr_b16 v[174:175], v251 offset:4736
    ds_read_b64_tr_b16 v[176:177], v250 offset:12288
    ds_read_b64_tr_b16 v[178:179], v250 offset:15360
    ds_read_b64_tr_b16 v[180:181], v251 offset:12288
    ds_read_b64_tr_b16 v[182:183], v251 offset:15360
    ds_read_b64_tr_b16 v[184:185], v250 offset:12352
    ds_read_b64_tr_b16 v[186:187], v250 offset:15424
    ds_read_b64_tr_b16 v[188:189], v251 offset:12352
    ds_read_b64_tr_b16 v[190:191], v251 offset:15424
    ds_read_b64_tr_b16 v[192:193], v250 offset:12416
    ds_read_b64_tr_b16 v[194:195], v250 offset:15488
    ds_read_b64_tr_b16 v[196:197], v251 offset:12416
    ds_read_b64_tr_b16 v[198:199], v251 offset:15488
    ds_read_b64_tr_b16 v[200:201], v250 offset:13824
    ds_read_b64_tr_b16 v[202:203], v250 offset:16896
    ds_read_b64_tr_b16 v[204:205], v251 offset:13824
    ds_read_b64_tr_b16 v[206:207], v251 offset:16896
    ds_read_b64_tr_b16 v[208:209], v250 offset:13888
    ds_read_b64_tr_b16 v[210:211], v250 offset:16960
    ds_read_b64_tr_b16 v[212:213], v251 offset:13888
    ds_read_b64_tr_b16 v[214:215], v251 offset:16960
    ds_read_b64_tr_b16 v[216:217], v250 offset:13952
    ds_read_b64_tr_b16 v[218:219], v250 offset:17024
    ds_read_b64_tr_b16 v[220:221], v251 offset:13952
    ds_read_b64_tr_b16 v[222:223], v251 offset:17024
    s_mul_i32 s54, s48, 6144
    s_add_u32 s54, s54, 31232
    v_lshlrev_b32 v30, 6, v12
    v_xor_b32 v30, v30, v11
    v_add_u32 v30, s54, v30
    s_lshl_b32 s54, s48, 9
    s_add_u32 s54, s54, 55808
    v_lshlrev_b32 v31, 3, v0
    v_add_u32 v31, s54, v31
    v_lshrrev_b32 v36, 2, v0
    v_and_b32 v37, 3, v0
    v_lshlrev_b32 v38, 2, v37
    v_xor_b32 v38, v38, v36
    v_lshl_add_u32 v38, v37, 4, v38
    v_lshlrev_b32 v38, 4, v38
    s_and_b32 s54, s48, 1
    s_lshr_b32 s55, s48, 1
    s_mul_i32 s56, s54, 6144
    s_mul_i32 s57, s55, 3072
    s_add_u32 s56, s56, s57
    s_add_u32 s56, s56, 31232
    v_add_u32 v248, s56, v38
    s_lshl_b32 s56, s54, 9
    s_add_u32 s56, s56, 55808
    v_lshlrev_b32 v39, 3, v36
    v_add_u32 v249, s56, v39
    v_lshlrev_b32 v39, 3, v13
    v_add_u32 v253, s56, v39
    v_lshlrev_b32 v36, 15, v36
    v_lshl_add_u32 v254, v37, 4, v36
    s_mov_b32 s58, 0
    s_waitcnt vmcnt(0)
L_chk_C:
    v_cmpx_eq_u32 vcc, s53, v67
    v_cmpx_eq_u32 vcc, s53, v71
    v_cmpx_eq_u32 vcc, s53, v75
    v_cmpx_eq_u32 vcc, s53, v79
    v_cmpx_eq_u32 vcc, s53, v83
    v_cmpx_eq_u32 vcc, s53, v87
    v_cmpx_eq_u32 vcc, s53, v91
    v_cmpx_eq_u32 vcc, s53, v95
    s_nop 1
    s_cmp_eq_u64 exec, -1
    s_mov_b64 exec, -1
    s_cbranch_scc1 L_ok_C
    s_add_u32 s58, s58, 1
    s_cmp_gt_u32 s58, 40000
    s_cbranch_scc1 L_exit
    buffer_load_dwordx4 v[64:67], v252, s[32:35], s75 offen sc1
    buffer_load_dwordx4 v[80:83], v252, s[32:35], s75 offen offset:512 sc1
    s_add_u32 s54, s75, 4096
    buffer_load_dwordx4 v[68:71], v252, s[32:35], s54 offen sc1
    buffer_load_dwordx4 v[84:87], v252, s[32:35], s54 offen offset:512 sc1
    s_add_u32 s54, s75, 8192
    buffer_load_dwordx4 v[72:75], v252, s[32:35], s54 offen sc1
    buffer_load_dwordx4 v[88:91], v252, s[32:35], s54 offen offset:512 sc1
    s_add_u32 s54, s75, 12288
    buffer_load_dwordx4 v[76:79], v252, s[32:35], s54 offen sc1
    buffer_load_dwordx4 v[92:95], v252, s[32:35], s54 offen offset:512 sc1
    s_waitcnt vmcnt(0)
    s_branch L_chk_C
L_ok_C:
    v_max3_f32 v32, v81, v85, v89
    v_max_f32 v32, v32, v93
    v_mov_b32 v33, v32
    s_nop 1
    v_permlane32_swap_b32 v33, v32
    v_max_f32 v32, v33, v32
    v_sub_f32 v36, v32, v81
    v_sub_f32 v37, v32, v85
    v_sub_f32 v38, v32, v89
    v_sub_f32 v39, v32, v93
    s_mov_b32 s54, 0x800080
    v_min_f32 v40, 0x437f0000, v36
    v_min_f32 v41, 0x437f0000, v37
    v_min_f32 v42, 0x437f0000, v38
    v_min_f32 v43, 0x437f0000, v39
    v_cvt_u32_f32 v40, v40
    v_cvt_u32_f32 v41, v41
    v_cvt_u32_f32 v42, v42
    v_cvt_u32_f32 v43, v43
    v_mul_u32_u24 v40, s54, v40
    v_mul_u32_u24 v41, s54, v41
    v_mul_u32_u24 v42, s54, v42
    v_mul_u32_u24 v43, s54, v43
    v_pk_sub_u16 v64, v64, v40 clamp
    v_pk_sub_u16 v65, v65, v40 clamp
    v_pk_sub_u16 v66, v66, v40 clamp
    v_pk_sub_u16 v67, v80, v40 clamp
    s_waitcnt lgkmcnt(0)
    s_nop 0
    v_mfma_f32_16x16x32_bf16 v[224:227], v[128:131], v[64:67], 0
    v_mfma_f32_16x16x32_bf16 v[228:231], v[132:135], v[64:67], 0
    v_pk_sub_u16 v68, v68, v41 clamp
    v_pk_sub_u16 v69, v69, v41 clamp
    v_pk_sub_u16 v70, v70, v41 clamp
    v_pk_sub_u16 v71, v84, v41 clamp
    v_mfma_f32_16x16x32_bf16 v[232:235], v[136:139], v[64:67], 0
    v_mfma_f32_16x16x32_bf16 v[236:239], v[140:143], v[64:67], 0
    v_mfma_f32_16x16x32_bf16 v[240:243], v[144:147], v[64:67], 0
    v_mfma_f32_16x16x32_bf16 v[244:247], v[148:151], v[64:67], 0
    v_exp_f32 v36, -v36
    v_exp_f32 v37, -v37
    v_exp_f32 v38, -v38
    v_exp_f32 v39, -v39
    v_mul_f32 v33, v36, v82
    v_fmac_f32 v33, v37, v86
    v_fmac_f32 v33, v38, v90
    v_fmac_f32 v33, v39, v94
    v_mov_b32 v34, v33
    s_nop 1
    v_permlane32_swap_b32 v34, v33
    v_add_f32 v33, v34, v33
    ds_write_b64 v31, v[32:33]
    v_mfma_f32_16x16x32_bf16 v[224:227], v[152:155], v[68:71], v[224:227]
    v_mfma_f32_16x16x32_bf16 v[228:231], v[156:159], v[68:71], v[228:231]
    v_pk_sub_u16 v72, v72, v42 clamp
    v_pk_sub_u16 v73, v73, v42 clamp
    v_pk_sub_u16 v74, v74, v42 clamp
    v_pk_sub_u16 v75, v88, v42 clamp
    v_mfma_f32_16x16x32_bf16 v[232:235], v[160:163], v[68:71], v[232:235]
    s_and_b32 s95, s48, 1
    s_mul_i32 s95, s95, 221184
    s_add_u32 s95, s95, s79
    s_add_u32 s97, s95, 196608
    buffer_load_dwordx4 a[104:107], v6, s[20:23], s97 offen
    v_mfma_f32_16x16x32_bf16 v[236:239], v[164:167], v[68:71], v[236:239]
    v_mfma_f32_16x16x32_bf16 v[240:243], v[168:171], v[68:71], v[240:243]
    v_mfma_f32_16x16x32_bf16 v[244:247], v[172:175], v[68:71], v[244:247]
    buffer_load_dwordx4 a[120:123], v7, s[20:23], s97 offen
    v_mfma_f32_16x16x32_bf16 v[224:227], v[176:179], v[72:75], v[224:227]
    v_mfma_f32_16x16x32_bf16 v[228:231], v[180:183], v[72:75], v[228:231]
    v_pk_sub_u16 v76, v76, v43 clamp
    v_pk_sub_u16 v77, v77, v43 clamp
    v_pk_sub_u16 v78, v78, v43 clamp
    v_pk_sub_u16 v79, v92, v43 clamp
    s_and_b32 s95, s48, 1
    s_mul_i32 s95, s95, 221184
    s_add_u32 s95, s95, s79
    s_add_u32 s97, s95, 208896
    buffer_load_dwordx4 a[108:111], v6, s[20:23], s97 offen
    v_mfma_f32_16x16x32_bf16 v[232:235], v[184:187], v[72:75], v[232:235]
    v_mfma_f32_16x16x32_bf16 v[236:239], v[188:191], v[72:75], v[236:239]
    v_mfma_f32_16x16x32_bf16 v[240:243], v[192:195], v[72:75], v[240:243]
    s_mov_b32 s99, s80
    buffer_load_dwordx4 a[136:139], v9, s[24:27], s99 offen offset:0
    v_mfma_f32_16x16x32_bf16 v[244:247], v[196:199], v[72:75], v[244:247]
    v_mfma_f32_16x16x32_bf16 v[224:227], v[200:203], v[76:79], v[224:227]
    buffer_load_dwordx4 a[140:143], v9, s[24:27], s99 offen offset:256
    v_mfma_f32_16x16x32_bf16 v[228:231], v[204:207], v[76:79], v[228:231]
    v_mfma_f32_16x16x32_bf16 v[232:235], v[208:211], v[76:79], v[232:235]
    v_mfma_f32_16x16x32_bf16 v[236:239], v[212:215], v[76:79], v[236:239]
    buffer_load_dwordx4 a[144:147], v9, s[24:27], s99 offen offset:512
    v_mfma_f32_16x16x32_bf16 v[240:243], v[216:219], v[76:79], v[240:243]
    v_mfma_f32_16x16x32_bf16 v[244:247], v[220:223], v[76:79], v[244:247]
    buffer_load_dwordx4 a[148:151], v9, s[24:27], s99 offen offset:768
    ds_write_b128 v30, v[224:227] offset:0
    s_nop 0
    ds_write_b128 v30, v[228:231] offset:1024
    ds_write_b128 v30, v[232:235] offset:2048
    ds_write_b128 v30, v[236:239] offset:3072
    s_nop 0
    ds_write_b128 v30, v[240:243] offset:4096
    ds_write_b128 v30, v[244:247] offset:5120
    s_waitcnt lgkmcnt(0)
    s_barrier
    ds_read_b64 v[30:31], v249
    ds_read_b64 v[32:33], v249 offset:1024
    ds_read_b128 v[36:39], v248 offset:0
    ds_read_b128 v[48:51], v248 offset:12288
    ds_read_b128 v[40:43], v248 offset:1024
    ds_read_b128 v[52:55], v248 offset:13312
    ds_read_b128 v[44:47], v248 offset:2048
    ds_read_b128 v[56:59], v248 offset:14336
    s_waitcnt lgkmcnt(6)
    v_max_f32 v34, v30, v32
    v_sub_f32 v30, v30, v34
    v_sub_f32 v32, v32, v34
    v_exp_f32 v30, v30
    v_exp_f32 v32, v32
    v_mov_b32 v63, v1
    s_waitcnt lgkmcnt(0)
    v_pk_mul_f32 v[36:37], v[36:37], v[30:31] op_sel_hi:[1,0]
    v_pk_mul_f32 v[38:39], v[38:39], v[30:31] op_sel_hi:[1,0]
    v_pk_mul_f32 v[40:41], v[40:41], v[30:31] op_sel_hi:[1,0]
    v_pk_mul_f32 v[42:43], v[42:43], v[30:31] op_sel_hi:[1,0]
    v_pk_mul_f32 v[44:45], v[44:45], v[30:31] op_sel_hi:[1,0]
    v_pk_mul_f32 v[46:47], v[46:47], v[30:31] op_sel_hi:[1,0]
    v_pk_fma_f32 v[36:37], v[48:49], v[32:33], v[36:37] op_sel_hi:[1,0,1]
    v_pk_fma_f32 v[38:39], v[50:51], v[32:33], v[38:39] op_sel_hi:[1,0,1]
    v_pk_fma_f32 v[40:41], v[52:53], v[32:33], v[40:41] op_sel_hi:[1,0,1]
    v_pk_fma_f32 v[42:43], v[54:55], v[32:33], v[42:43] op_sel_hi:[1,0,1]
    v_pk_fma_f32 v[44:45], v[56:57], v[32:33], v[44:45] op_sel_hi:[1,0,1]
    v_pk_fma_f32 v[46:47], v[58:59], v[32:33], v[46:47] op_sel_hi:[1,0,1]
    v_cvt_pk_bf16_f32 v56, v36, v37
    v_cvt_pk_bf16_f32 v60, v42, v43
    v_cvt_pk_bf16_f32 v57, v38, v39
    v_cvt_pk_bf16_f32 v61, v44, v45
    v_cvt_pk_bf16_f32 v58, v40, v41
    v_cvt_pk_bf16_f32 v62, v46, v47
    v_mov_b32 v59, v1
    buffer_store_dwordx4 v[56:59], v254, s[32:35], s76 offen sc1
    buffer_store_dwordx4 v[60:63], v254, s[32:35], s76 offen offset:64 sc1
    ds_read_b64 v[30:31], v253
    ds_read_b64 v[32:33], v253 offset:1024
    s_cmp_lt_u32 s48, 2
    s_cselect_b32 s55, 16, 0
    v_mov_b32 v44, 2130706432
    v_cmp_gt_u32 vcc, s55, v0
    s_nop 1
    v_cndmask_b32 v44, v44, v11, vcc
    s_waitcnt lgkmcnt(0)
    v_max_f32 v36, v30, v32
    v_sub_f32 v30, v30, v36
    v_sub_f32 v32, v32, v36
    v_exp_f32 v30, v30
    v_exp_f32 v32, v32
    v_mov_b32 v38, 0
    v_mov_b32 v39, v1
    v_mul_f32 v37, v30, v31
    v_fmac_f32 v37, v32, v33
    buffer_store_dwordx4 v[36:39], v44, s[32:35], s77 offen sc1
    v_lshlrev_b32 v29, 7, v14
    v_mov_b32 v247, 2130706432
    v_cmp_gt_u32 vcc, 12, v14
    s_nop 1
    v_cndmask_b32 v29, v247, v29, vcc
    buffer_load_dword v246, v29, s[32:35], s83 offen
    buffer_load_dwordx4 a[152:155], v9, s[24:27], s99 offen offset:1024
    s_and_b32 s95, s48, 3
    s_mul_hi_u32 s95, s95, 0x55555556
    s_mul_i32 s95, s95, 39680
    s_sub_u32 s99, s99, s95
    s_add_u32 s99, s99, 40960
    buffer_load_dwordx4 a[156:159], v9, s[24:27], s99 offen offset:0
    buffer_load_dwordx4 a[160:163], v9, s[24:27], s99 offen offset:256
    buffer_load_dwordx4 a[164:167], v9, s[24:27], s99 offen offset:512
    buffer_load_dwordx4 a[168:171], v9, s[24:27], s99 offen offset:768
    buffer_load_dwordx4 a[172:175], v9, s[24:27], s99 offen offset:1024
    s_and_b32 s54, s48, 1
    s_lshl_b32 s54, s54, 3
    v_add_u32 v30, v13, v12
    v_add_u32 v30, s54, v30
    v_and_b32 v30, 15, v30
    v_lshlrev_b32 v30, 12, v30
    s_waitcnt vmcnt(0)
    buffer_load_dwordx4 v[64:67], v30, s[32:35], s81 offen sc1
    buffer_load_dwordx4 v[68:71], v11, s[32:35], s82 offen sc1
    buffer_load_dwordx4 v[72:75], v11, s[32:35], s82 offen offset:1024 sc1
    v_bfe_u32 v31, v0, 2, 2
    v_and_b32 v32, 3, v0
    s_cmp_eq_u32 s48, 3
    s_cselect_b32 s54, 10, 11
    v_lshlrev_b32 v252, s54, v31
    v_lshl_add_u32 v252, v32, 4, v252
    s_cbranch_scc0 L_noh
    buffer_load_dwordx4 v[80:83], v252, s[32:35], s90 offen sc1
    s_add_u32 s56, s90, 4096
    buffer_load_dwordx4 v[84:87], v252, s[32:35], s56 offen sc1
    s_add_u32 s56, s90, 8192
    buffer_load_dwordx4 v[88:91], v252, s[32:35], s56 offen sc1
    s_add_u32 s56, s90, 12288
    buffer_load_dwordx4 v[92:95], v252, s[32:35], s56 offen sc1
    s_add_u32 s56, s90, 16384
    buffer_load_dwordx4 v[96:99], v252, s[32:35], s56 offen sc1
L_noh:
    s_and_b32 s54, s48, 1
    s_lshl_b32 s54, s54, 11
    s_lshr_b32 s55, s48, 1
    s_lshl_b32 s55, s55, 10
    s_add_u32 s54, s54, s55
    s_add_u32 s54, s54, 26880
    v_add_u32 v33, s54, v11
    v_bfe_u32 v34, v0, 3, 1
    v_lshlrev_b32 v34, 10, v34
    v_lshl_add_u32 v34, v12, 2, v34
    s_lshl_b32 s54, s48, 8
    s_add_u32 s54, s54, 26880
    v_add_u32 v34, s54, v34
    v_min_u32 v35, 95, v14
    v_mul_u32_u24 v36, 5462, v35
    v_lshrrev_b32 v36, 16, v36
    v_mul_u32_u24 v37, 12, v36
    v_sub_u32 v37, v35, v37
    v_lshrrev_b32 v37, 1, v37
    v_and_b32 v38, 1, v35
    v_lshl_add_u32 v36, v38, 3, v36
    v_xor_b32 v36, v36, v37
    v_lshl_add_u32 v36, v37, 4, v36
    v_lshlrev_b32 v248, 4, v36
    v_lshlrev_b32 v59, 4, v12
    v_xor_b32 v58, v59, v19
    v_xor_b32 v59, 64, v58
    v_lshlrev_b32 v249, 4, v14
    v_mov_b32 v36, 2130706432
    v_cmp_gt_u32 vcc, 96, v14
    s_nop 1
    v_cndmask_b32 v249, v36, v249, vcc
    v_cmp_eq_u32 s[60:61], 1, v12
    v_cmp_eq_u32 s[62:63], 2, v12
    v_cmp_eq_u32 s[46:47], 3, v12
    v_cmp_gt_u32 vcc, 8, v13
    s_mov_b32 s58, 0
    s_waitcnt vmcnt(0)
L_chk_D:
    v_cmpx_eq_u32 vcc, s53, v67
    v_cmpx_eq_u32 vcc, s53, v71
    v_cmpx_eq_u32 vcc, s53, v75
    s_nop 1
    s_cmp_eq_u64 exec, -1
    s_mov_b64 exec, -1
    s_cbranch_scc1 L_ok_D
    s_add_u32 s58, s58, 1
    s_cmp_gt_u32 s58, 40000
    s_cbranch_scc1 L_exit
    buffer_load_dwordx4 v[64:67], v30, s[32:35], s81 offen sc1
    buffer_load_dwordx4 v[68:71], v11, s[32:35], s82 offen sc1
    buffer_load_dwordx4 v[72:75], v11, s[32:35], s82 offen offset:1024 sc1
    s_waitcnt vmcnt(0)
    s_branch L_chk_D
L_ok_D:
    v_mov_b32 v36, v64
    s_nop 1
    v_max_f32_dpp v37, v36, v36 quad_perm:[1,0,3,2] row_mask:0xf bank_mask:0xf
    s_nop 1
    v_max_f32_dpp v36, v37, v37 quad_perm:[2,3,0,1] row_mask:0xf bank_mask:0xf
    s_nop 1
    v_max_f32_dpp v37, v36, v36 row_half_mirror row_mask:0xf bank_mask:0xf
    s_nop 1
    v_max_f32_dpp v36, v37, v37 row_mirror row_mask:0xf bank_mask:0xf
    v_sub_f32 v36, v64, v36
    v_exp_f32 v36, v36
    s_nop 0
    v_mul_f32 v37, v36, v65
    s_nop 1
    v_add_f32_dpp v38, v37, v37 quad_perm:[1,0,3,2] row_mask:0xf bank_mask:0xf
    s_nop 1
    v_add_f32_dpp v37, v38, v38 quad_perm:[2,3,0,1] row_mask:0xf bank_mask:0xf
    s_nop 1
    v_add_f32_dpp v38, v37, v37 row_half_mirror row_mask:0xf bank_mask:0xf
    s_nop 1
    v_add_f32_dpp v37, v38, v38 row_mirror row_mask:0xf bank_mask:0xf
    v_rcp_f32 v37, v37
    s_nop 0
    v_mul_f32 v36, v36, v37
    v_cvt_pk_bf16_f32 v37, v36, v36
    s_nop 1
    v_mov_b32_dpp v39, v37 row_newbcast:0 row_mask:0xf bank_mask:0xf
    v_mov_b32_dpp v41, v37 row_newbcast:4 row_mask:0xf bank_mask:0xf
    v_and_b32 v44, v39, v2
    v_and_b32 v45, v39, v3
    v_and_b32 v46, v39, v4
    v_and_b32 v47, v39, v5
    v_and_b32 v48, v41, v2
    v_and_b32 v49, v41, v3
    v_and_b32 v50, v41, v4
    v_and_b32 v51, v41, v5
    v_mfma_f32_16x16x32_bf16 v[36:39], v[68:71], v[44:47], 0
    s_nop 0
    v_mfma_f32_16x16x32_bf16 v[36:39], v[72:75], v[48:51], v[36:39]
    s_nop 7
    ds_write_b128 v33, v[36:39]
    s_waitcnt lgkmcnt(0)
    s_barrier
    ds_read_b32 v36, v34 offset:0
    ds_read_b32 v42, v34 offset:2048
    ds_read_b32 v37, v34 offset:16
    ds_read_b32 v43, v34 offset:2064
    ds_read_b32 v38, v34 offset:32
    ds_read_b32 v44, v34 offset:2080
    ds_read_b32 v39, v34 offset:48
    ds_read_b32 v45, v34 offset:2096
    ds_read_b32 v40, v34 offset:64
    ds_read_b32 v46, v34 offset:2112
    ds_read_b32 v41, v34 offset:80
    ds_read_b32 v47, v34 offset:2128
    s_add_u32 s56, s83, 524288
    s_waitcnt lgkmcnt(0)
    v_add_f32 v36, v36, v42
    v_add_f32 v37, v37, v43
    v_add_f32 v38, v38, v44
    v_add_f32 v39, v39, v45
    v_add_f32 v40, v40, v46
    v_add_f32 v41, v41, v47
    v_cvt_pk_bf16_f32 v36, v36, v36
    v_cvt_pk_bf16_f32 v37, v37, v37
    v_cvt_pk_bf16_f32 v38, v38, v38
    v_cvt_pk_bf16_f32 v39, v39, v39
    v_cvt_pk_bf16_f32 v40, v40, v40
    v_cvt_pk_bf16_f32 v41, v41, v41
    s_waitcnt vmcnt(17)
    v_and_b32 v128, v36, v2
    v_and_b32 v129, v36, v3
    v_and_b32 v130, v36, v4
    v_and_b32 v131, v36, v5
    v_and_b32 v132, v37, v2
    v_and_b32 v133, v37, v3
    v_and_b32 v134, v37, v4
    v_and_b32 v135, v37, v5
    v_mfma_f32_16x16x32_bf16 v[224:227], a[88:91], v[128:131], 0
    v_mfma_f32_16x16x32_bf16 v[228:231], a[112:115], v[128:131], 0
    v_and_b32 v136, v38, v2
    v_and_b32 v137, v38, v3
    v_and_b32 v138, v38, v4
    v_and_b32 v139, v38, v5
    v_mfma_f32_16x16x32_bf16 v[224:227], a[92:95], v[132:135], v[224:227]
    v_mfma_f32_16x16x32_bf16 v[232:235], a[112:115], v[132:135], 0
    v_and_b32 v140, v39, v2
    v_and_b32 v141, v39, v3
    v_and_b32 v142, v39, v4
    v_and_b32 v143, v39, v5
    v_mfma_f32_16x16x32_bf16 v[224:227], a[96:99], v[136:139], v[224:227]
    v_mfma_f32_16x16x32_bf16 v[228:231], a[116:119], v[136:139], v[228:231]
    v_and_b32 v144, v40, v2
    v_and_b32 v145, v40, v3
    v_and_b32 v146, v40, v4
    v_and_b32 v147, v40, v5
    v_mfma_f32_16x16x32_bf16 v[224:227], a[100:103], v[140:143], v[224:227]
    v_mfma_f32_16x16x32_bf16 v[232:235], a[116:119], v[140:143], v[232:235]
    v_and_b32 v148, v41, v2
    v_and_b32 v149, v41, v3
    v_and_b32 v150, v41, v4
    v_and_b32 v151, v41, v5
    v_mfma_f32_16x16x32_bf16 v[224:227], a[104:107], v[144:147], v[224:227]
    v_mfma_f32_16x16x32_bf16 v[228:231], a[120:123], v[144:147], v[228:231]
    v_mfma_f32_16x16x32_bf16 v[224:227], a[108:111], v[148:151], v[224:227]
    v_mfma_f32_16x16x32_bf16 v[232:235], a[120:123], v[148:151], v[232:235]
    s_nop 7
    v_mov_b32 v52, v232
    v_mov_b32 v53, v233
    v_mov_b32 v54, v234
    v_mov_b32 v55, v235
    v_permlane32_swap_b32 v52, v232
    v_permlane32_swap_b32 v53, v233
    v_permlane32_swap_b32 v54, v234
    v_permlane32_swap_b32 v55, v235
    v_add_f32 v228, v228, v232
    v_add_f32 v229, v229, v233
    v_add_f32 v230, v230, v234
    v_add_f32 v231, v231, v235
    ds_write_b128 v58, v[224:227]
    ds_write_b128 v59, v[228:231] offset:1024
    s_waitcnt lgkmcnt(0)
    s_barrier
    ds_read_b128 v[36:39], v248
    ds_read_b128 v[40:43], v248 offset:5120
    ds_read_b128 v[44:47], v248 offset:10240
    ds_read_b128 v[48:51], v248 offset:15360
    v_mov_b32 v59, v1
    s_waitcnt lgkmcnt(0)
    v_pk_add_f32 v[36:37], v[36:37], v[40:41]
    v_pk_add_f32 v[44:45], v[44:45], v[48:49]
    v_pk_add_f32 v[38:39], v[38:39], v[42:43]
    v_pk_add_f32 v[46:47], v[46:47], v[50:51]
    v_pk_add_f32 v[36:37], v[36:37], v[44:45]
    v_pk_add_f32 v[38:39], v[38:39], v[46:47]
    v_perm_b32 v56, v36, v39, s3
    v_perm_b32 v57, v37, v39, s4
    v_perm_b32 v58, v38, v39, s5
    s_cmp_eq_u32 s41, 0
    s_cbranch_scc1 L_wt2
    buffer_store_dwordx4 v[56:59], v249, s[32:35], s83 offen
    s_branch L_wd2
L_wt2:
    buffer_store_dwordx4 v[56:59], v249, s[32:35], s83 offen sc1
L_wd2:
    s_cmp_eq_u32 s48, 3
    s_cbranch_scc1 L_hgather
    buffer_load_dwordx4 v[64:67], v252, s[32:35], s84 offen sc1
    s_add_u32 s54, s84, 8192
    buffer_load_dwordx4 v[68:71], v252, s[32:35], s54 offen sc1
    s_mov_b32 s58, 0
    s_waitcnt vmcnt(0)
L_chk_E:
    v_cmpx_eq_u32 vcc, s53, v67
    v_cmpx_eq_u32 vcc, s53, v71
    s_nop 1
    s_cmp_eq_u64 exec, -1
    s_mov_b64 exec, -1
    s_cbranch_scc1 L_ok_E
    s_add_u32 s58, s58, 1
    s_cmp_gt_u32 s58, 40000
    s_cbranch_scc1 L_exit
    buffer_load_dwordx4 v[64:67], v252, s[32:35], s84 offen sc1
    s_add_u32 s54, s84, 8192
    buffer_load_dwordx4 v[68:71], v252, s[32:35], s54 offen sc1
    s_waitcnt vmcnt(0)
    s_branch L_chk_E
L_ok_E:
    v_perm_b32 v41, v64, v65, s6
    v_perm_b32 v40, v41, v66, s7
    v_cndmask_b32 v36, v64, v65, s[60:61]
    v_cndmask_b32 v36, v36, v66, s[62:63]
    v_cndmask_b32 v36, v36, v40, s[46:47]
    v_perm_b32 v43, v68, v69, s6
    v_perm_b32 v42, v43, v70, s7
    v_cndmask_b32 v37, v68, v69, s[60:61]
    v_cndmask_b32 v37, v37, v70, s[62:63]
    v_cndmask_b32 v37, v37, v42, s[46:47]
    v_add_f32 v36, v36, v37
    s_branch L_ejoin
L_hgather:
    s_mov_b32 s58, 0
    s_waitcnt vmcnt(0)
L_chk_H:
    v_cmpx_eq_u32 vcc, s53, v83
    v_cmpx_eq_u32 vcc, s53, v87
    v_cmpx_eq_u32 vcc, s53, v91
    v_cmpx_eq_u32 vcc, s53, v95
    v_cmpx_eq_u32 vcc, s53, v99
    s_nop 1
    s_cmp_eq_u64 exec, -1
    s_mov_b64 exec, -1
    s_cbranch_scc1 L_ok_H
    s_add_u32 s58, s58, 1
    s_cmp_gt_u32 s58, 40000
    s_cbranch_scc1 L_exit
    buffer_load_dwordx4 v[80:83], v252, s[32:35], s90 offen sc1
    s_add_u32 s56, s90, 4096
    buffer_load_dwordx4 v[84:87], v252, s[32:35], s56 offen sc1
    s_add_u32 s56, s90, 8192
    buffer_load_dwordx4 v[88:91], v252, s[32:35], s56 offen sc1
    s_add_u32 s56, s90, 12288
    buffer_load_dwordx4 v[92:95], v252, s[32:35], s56 offen sc1
    s_add_u32 s56, s90, 16384
    buffer_load_dwordx4 v[96:99], v252, s[32:35], s56 offen sc1
    s_waitcnt vmcnt(0)
    s_branch L_chk_H
L_ok_H:
    v_perm_b32 v41, v80, v81, s6
    v_perm_b32 v40, v41, v82, s7
    v_cndmask_b32 v44, v80, v81, s[60:61]
    v_cndmask_b32 v44, v44, v82, s[62:63]
    v_cndmask_b32 v44, v44, v40, s[46:47]
    v_perm_b32 v41, v84, v85, s6
    v_perm_b32 v40, v41, v86, s7
    v_cndmask_b32 v45, v84, v85, s[60:61]
    v_cndmask_b32 v45, v45, v86, s[62:63]
    v_cndmask_b32 v45, v45, v40, s[46:47]
    v_perm_b32 v41, v88, v89, s6
    v_perm_b32 v40, v41, v90, s7
    v_cndmask_b32 v46, v88, v89, s[60:61]
    v_cndmask_b32 v46, v46, v90, s[62:63]
    v_cndmask_b32 v46, v46, v40, s[46:47]
    v_perm_b32 v41, v92, v93, s6
    v_perm_b32 v40, v41, v94, s7
    v_cndmask_b32 v47, v92, v93, s[60:61]
    v_cndmask_b32 v47, v47, v94, s[62:63]
    v_cndmask_b32 v47, v47, v40, s[46:47]
    v_perm_b32 v41, v96, v97, s6
    v_perm_b32 v40, v41, v98, s7
    v_cndmask_b32 v48, v96, v97, s[60:61]
    v_cndmask_b32 v48, v48, v98, s[62:63]
    v_cndmask_b32 v48, v48, v40, s[46:47]
    v_add_f32 v44, v44, v45
    v_add_f32 v46, v46, v47
    v_add_f32 v44, v44, v48
    v_add_f32 v36, v44, v46
L_ejoin:
    v_cmp_gt_u32 vcc, 8, v13
    s_nop 0
    v_add_f32_dpp v37, v36, v36 row_ror:4 row_mask:0xf bank_mask:0xf
    s_nop 1
    v_add_f32_dpp v36, v37, v37 row_ror:8 row_mask:0xf bank_mask:0xf
    s_nop 1
    v_mov_b32_dpp v38, v36 quad_perm:[0,0,0,0] row_mask:0xf bank_mask:0xf
    v_mov_b32_dpp v39, v36 quad_perm:[1,1,1,1] row_mask:0xf bank_mask:0xf
    v_mov_b32_dpp v40, v36 quad_perm:[2,2,2,2] row_mask:0xf bank_mask:0xf
    v_mov_b32_dpp v41, v36 quad_perm:[3,3,3,3] row_mask:0xf bank_mask:0xf
    v_cndmask_b32 v36, v39, v38, vcc
    v_cndmask_b32 v37, v41, v40, vcc
    s_cmp_eq_u32 s48, 3
    s_cbranch_scc0 L_noact
    v_lshlrev_b32 v38, 16, v16
    v_and_b32 v39, 0xffff0000, v16
    v_add_f32 v36, v36, v38
    v_max_f32 v36, 0, v36
    v_mul_f32 v36, v36, v36
    v_add_f32 v37, v37, v39
    v_max_f32 v37, 0, v37
    v_mul_f32 v37, v37, v37
    s_cmp_lt_u32 s2, 192
    s_cbranch_scc1 L_noact
    v_mov_b32 v36, 0
    v_mov_b32 v37, 0
L_noact:
    v_cvt_pk_bf16_f32 v36, v36, v36
    v_cvt_pk_bf16_f32 v37, v37, v37
    v_and_b32 v40, v36, v2
    v_and_b32 v41, v36, v3
    v_and_b32 v42, v36, v4
    v_and_b32 v43, v36, v5
    v_and_b32 v44, v37, v2
    v_and_b32 v45, v37, v3
    v_and_b32 v46, v37, v4
    v_and_b32 v47, v37, v5
    v_lshlrev_b32 v32, 4, v14
    v_lshrrev_b32 v33, 2, v14
    v_lshlrev_b32 v33, 14, v33
    v_and_b32 v34, 3, v14
    v_lshl_add_u32 v33, v34, 4, v33
    v_min_u32 v34, 63, v14
    v_lshlrev_b32 v34, 4, v34
    v_add_u32 v34, 35328, v34
    v_add_u32 v32, 31232, v32
    v_add_u32 v30, 31232, v19
    s_add_u32 s55, s85, 1048576
    s_waitcnt vmcnt(7)
    v_mfma_f32_16x16x32_bf16 v[224:227], a[136:139], v[40:43], 0
    v_mfma_f32_16x16x32_bf16 v[228:231], a[140:143], v[40:43], 0
    v_mfma_f32_16x16x32_bf16 v[232:235], a[144:147], v[40:43], 0
    v_mfma_f32_16x16x32_bf16 v[236:239], a[148:151], v[40:43], 0
    v_mfma_f32_16x16x32_bf16 v[240:243], a[152:155], v[40:43], 0
    v_mfma_f32_16x16x32_bf16 v[224:227], a[156:159], v[44:47], v[224:227]
    v_mfma_f32_16x16x32_bf16 v[228:231], a[160:163], v[44:47], v[228:231]
    v_mfma_f32_16x16x32_bf16 v[232:235], a[164:167], v[44:47], v[232:235]
    v_mfma_f32_16x16x32_bf16 v[236:239], a[168:171], v[44:47], v[236:239]
    v_mfma_f32_16x16x32_bf16 v[240:243], a[172:175], v[44:47], v[240:243]
    s_nop 3
    ds_write_b128 v30, v[224:227] offset:0
    ds_write_b128 v30, v[228:231] offset:1024
    ds_write_b128 v30, v[232:235] offset:2048
    ds_write_b128 v30, v[236:239] offset:3072
    ds_write_b128 v30, v[240:243] offset:4096
    s_waitcnt lgkmcnt(0)
    s_barrier
    ds_read_b128 v[36:39], v32
    ds_read_b128 v[40:43], v32 offset:5120
    ds_read_b128 v[44:47], v32 offset:10240
    ds_read_b128 v[48:51], v32 offset:15360
    ds_read_b128 v[64:67], v34
    ds_read_b128 v[68:71], v34 offset:5120
    ds_read_b128 v[72:75], v34 offset:10240
    ds_read_b128 v[76:79], v34 offset:15360
    v_mov_b32 v31, v1
    v_mov_b32 v55, v1
    s_waitcnt lgkmcnt(0)
    v_pk_add_f32 v[36:37], v[36:37], v[40:41]
    v_pk_add_f32 v[44:45], v[44:45], v[48:49]
    v_pk_add_f32 v[38:39], v[38:39], v[42:43]
    v_pk_add_f32 v[46:47], v[46:47], v[50:51]
    v_pk_add_f32 v[36:37], v[36:37], v[44:45]
    v_pk_add_f32 v[38:39], v[38:39], v[46:47]
    v_perm_b32 v28, v36, v39, s3
    v_perm_b32 v29, v37, v39, s4
    v_perm_b32 v30, v38, v39, s5
    buffer_store_dwordx4 v[28:31], v33, s[32:35], s85 offen sc1
    s_cmp_lg_u32 s48, 0
    s_cbranch_scc1 L_nof2
    s_waitcnt lgkmcnt(0)
    v_pk_add_f32 v[64:65], v[64:65], v[68:69]
    v_pk_add_f32 v[72:73], v[72:73], v[76:77]
    v_pk_add_f32 v[66:67], v[66:67], v[70:71]
    v_pk_add_f32 v[74:75], v[74:75], v[78:79]
    v_pk_add_f32 v[64:65], v[64:65], v[72:73]
    v_pk_add_f32 v[66:67], v[66:67], v[74:75]
    v_perm_b32 v52, v64, v67, s3
    v_perm_b32 v53, v65, v67, s4
    v_perm_b32 v54, v66, v67, s5
    buffer_store_dwordx4 v[52:55], v33, s[32:35], s55 offen sc1
L_nof2:
    s_cmp_ge_u32 s2, 80
    s_cbranch_scc1 L_done
    v_and_b32 v33, 3, v0
    s_waitcnt vmcnt(0)
    buffer_load_dwordx4 v[64:67], v11, s[32:35], s86 offen offset:0 sc1
    buffer_load_dwordx4 v[68:71], v11, s[32:35], s86 offen offset:1024 sc1
    buffer_load_dwordx4 v[72:75], v11, s[32:35], s86 offen offset:2048 sc1
    buffer_load_dwordx4 v[76:79], v11, s[32:35], s86 offen offset:3072 sc1
    s_lshl_b32 s54, s48, 6
    s_add_u32 s54, s54, 30976
    v_lshlrev_b32 v33, 4, v33
    v_add_u32 v33, s54, v33
    v_and_b32 v34, 3, v0
    v_lshlrev_b32 v34, 4, v34
    v_bfe_u32 v35, v0, 2, 2
    v_lshl_add_u32 v34, v35, 2, v34
    v_add_u32 v34, 30976, v34
    v_mov_b32 v36, 2130706432
    v_cmp_gt_u32 vcc, 16, v0
    s_nop 1
    v_cndmask_b32 v35, v36, v17, vcc
    s_mov_b32 s58, 0
    s_waitcnt vmcnt(0)
L_chk_F:
    v_cmpx_eq_u32 vcc, s53, v67
    v_cmpx_eq_u32 vcc, s53, v71
    v_cmpx_eq_u32 vcc, s53, v75
    v_cmpx_eq_u32 vcc, s53, v79
    s_nop 1
    s_cmp_eq_u64 exec, -1
    s_mov_b64 exec, -1
    s_cbranch_scc1 L_ok_F
    s_add_u32 s58, s58, 1
    s_cmp_gt_u32 s58, 40000
    s_cbranch_scc1 L_exit
    buffer_load_dwordx4 v[64:67], v11, s[32:35], s86 offen offset:0 sc1
    buffer_load_dwordx4 v[68:71], v11, s[32:35], s86 offen offset:1024 sc1
    buffer_load_dwordx4 v[72:75], v11, s[32:35], s86 offen offset:2048 sc1
    buffer_load_dwordx4 v[76:79], v11, s[32:35], s86 offen offset:3072 sc1
    s_waitcnt vmcnt(0)
    s_branch L_chk_F
L_ok_F:
    v_perm_b32 v36, v64, v65, s6
    v_perm_b32 v67, v36, v66, s7
    v_perm_b32 v37, v68, v69, s6
    v_perm_b32 v71, v37, v70, s7
    v_perm_b32 v38, v72, v73, s6
    v_perm_b32 v75, v38, v74, s7
    v_perm_b32 v39, v76, v77, s6
    v_perm_b32 v79, v39, v78, s7
    v_add_f32 v64, v64, v68
    v_add_f32 v72, v72, v76
    v_add_f32 v65, v65, v69
    v_add_f32 v73, v73, v77
    v_add_f32 v66, v66, v70
    v_add_f32 v74, v74, v78
    v_add_f32 v67, v67, v71
    v_add_f32 v75, v75, v79
    v_add_f32 v64, v64, v72
    v_add_f32 v65, v65, v73
    v_add_f32 v66, v66, v74
    v_add_f32 v67, v67, v75
    v_add_f32_dpp v36, v64, v64 row_ror:4 row_mask:0xf bank_mask:0xf
    v_add_f32_dpp v37, v65, v65 row_ror:4 row_mask:0xf bank_mask:0xf
    v_add_f32_dpp v38, v66, v66 row_ror:4 row_mask:0xf bank_mask:0xf
    v_add_f32_dpp v39, v67, v67 row_ror:4 row_mask:0xf bank_mask:0xf
    v_add_f32_dpp v64, v36, v36 row_ror:8 row_mask:0xf bank_mask:0xf
    v_add_f32_dpp v65, v37, v37 row_ror:8 row_mask:0xf bank_mask:0xf
    v_add_f32_dpp v66, v38, v38 row_ror:8 row_mask:0xf bank_mask:0xf
    v_add_f32_dpp v67, v39, v39 row_ror:8 row_mask:0xf bank_mask:0xf
    v_mov_b32 v36, v64
    v_mov_b32 v37, v65
    v_mov_b32 v38, v66
    v_mov_b32 v39, v67
    v_permlane16_swap_b32 v36, v64
    v_permlane16_swap_b32 v37, v65
    v_permlane16_swap_b32 v38, v66
    v_permlane16_swap_b32 v39, v67
    v_add_f32 v64, v36, v64
    v_add_f32 v65, v37, v65
    v_add_f32 v66, v38, v66
    v_add_f32 v67, v39, v67
    v_mov_b32 v36, v64
    v_mov_b32 v37, v65
    v_mov_b32 v38, v66
    v_mov_b32 v39, v67
    v_permlane32_swap_b32 v36, v64
    v_permlane32_swap_b32 v37, v65
    v_permlane32_swap_b32 v38, v66
    v_permlane32_swap_b32 v39, v67
    v_add_f32 v64, v36, v64
    v_add_f32 v65, v37, v65
    v_add_f32 v66, v38, v66
    v_add_f32 v67, v39, v67
    s_mov_b64 exec, 15
    ds_write_b128 v33, v[64:67]
    s_mov_b64 exec, -1
    s_waitcnt lgkmcnt(0)
    s_barrier
    s_cmp_lg_u32 s48, 0
    s_cbranch_scc1 L_done
    ds_read_b32 v36, v34 offset:0
    ds_read_b32 v37, v34 offset:64
    ds_read_b32 v38, v34 offset:128
    ds_read_b32 v39, v34 offset:192
    s_waitcnt lgkmcnt(0)
    v_add_f32 v36, v36, v37
    v_add_f32 v38, v38, v39
    v_add_f32 v36, v36, v38
    v_add_f32 v36, v36, v15
    v_cvt_pk_bf16_f32 v36, v36, v36
    buffer_store_short v36, v35, s[36:39], 0 offen
    s_cmp_lg_u32 s2, 0
    s_cbranch_scc1 L_done
    v_mov_b32 v36, 2130706432
    v_cmp_eq_u32 vcc, 0, v0
    s_nop 1
    v_cndmask_b32 v36, v36, 0, vcc
    buffer_store_dword v1, v36, s[32:35], 0 offen sc1
L_done:
    s_waitcnt vmcnt(0)
L_exit:
    s_endpgm
L_code_end:
.section .rodata,"a"
.p2align 6
.amdhsa_kernel parallel_sum__compressed_kv_cla__dense_activation_squared_relu__decode_kernel
  .amdhsa_next_free_vgpr 512
  .amdhsa_next_free_sgpr 102
  .amdhsa_accum_offset 256
  .amdhsa_group_segment_fixed_size 0
  .amdhsa_kernarg_size 112
  .amdhsa_user_sgpr_count 2
  .amdhsa_user_sgpr_kernarg_segment_ptr 1
  .amdhsa_system_sgpr_workgroup_id_x 1
.end_amdhsa_kernel
```
